```python
import torch

def _softmax(x, axis=-1):
    return torch.softmax(x, dim=axis)

def _gelu(x):
    return torch.nn.functional.gelu(x, approximate='tanh')

def _silu(x):
    return torch.nn.functional.silu(x)

def _sigmoid(x):
    return torch.sigmoid(x)

def _layernorm(x, axis=-1, eps=1e-05):
    m = x.mean(dim=axis, keepdim=True)
    v = x.var(dim=axis, keepdim=True, unbiased=False)
    return (x - m) / torch.sqrt(v + eps)

def _scatter_add(tgt, idx, src, axis=0):
    return tgt.clone().index_add_(axis, idx, src)

def _segment_sum(src, seg, n):
    out = torch.zeros((n,) + src.shape[1:], dtype=src.dtype)
    return out.index_add_(0, seg, src)

def _pad(x, pw):
    flat = tuple((v for pair in reversed(pw) for v in pair))
    return torch.nn.functional.pad(x, flat)
kernel_name = 'recurrent_scan__linear_attn_block__mixer_gmlp__prompt'

def setup_inputs():

    _w = lambda a: (lambda t: t.to(torch.bfloat16) if t.is_floating_point() else t)(torch.as_tensor(a))

    def _A_setup():
        B, S, D = (1, 2048, 512)
        return {'x': _w((lambda *s: torch.randn(*s, dtype=torch.bfloat16) * 0.05)(B, S, D)), 'wqkv': _w((lambda *s: torch.randn(*s, dtype=torch.bfloat16) * 0.05)(D, 3 * D)), 'wo': _w((lambda *s: torch.randn(*s, dtype=torch.bfloat16) * 0.05)(D, D))}
    _A_in = _A_setup()

    def _B_setup():
        B, S, D, F = (1, 2048, 512, 1792)
        Fh = F // 2
        return {'x': _w((lambda *s: torch.randn(*s, dtype=torch.bfloat16) * 0.05)(B, S, D)), 'w_in': _w((lambda *s: torch.randn(*s, dtype=torch.bfloat16) * 0.8)(D, 2 * Fh)), 'w_sp': _w(0.01 * (lambda *s: torch.randn(*s, dtype=torch.bfloat16) * 0.8)(S, S)), 'b_sp': _w(1.0 + 0.01 * (lambda *s: torch.randn(*s, dtype=torch.bfloat16) * 0.05)(S)), 'w_out': _w((lambda *s: torch.randn(*s, dtype=torch.bfloat16) * 0.05)(Fh, D))}
    _B_in = _B_setup()
    return {'A_x': _A_in['x'], 'A_wqkv': _A_in['wqkv'], 'A_wo': _A_in['wo'], 'B_x': _B_in['x'], 'B_w_in': _B_in['w_in'], 'B_w_sp': _B_in['w_sp'], 'B_b_sp': _B_in['b_sp'], 'B_w_out': _B_in['w_out']}

def reference(A_x, A_wqkv, A_wo, B_x, B_w_in, B_w_sp, B_b_sp, B_w_out):

    def _A_ref(x, wqkv, wo):
        B, S, D = x.shape
        H = 32
        Dh = D // H
        qkv = (lambda x, *d: x.permute(*d))((x @ wqkv).reshape(B, S, 3, H, Dh), 2, 0, 3, 1, 4)
        q, k, v = (qkv[0], qkv[1], qkv[2])
        phi = lambda t: torch.where(t > 0, t + 1, torch.exp(t)) + 1e-06
        pq, pk = (phi(q), phi(k))
        kv = torch.einsum('bhsd,bhse->bhde', pk, v)
        z = torch.einsum('bhsd->bhd', pk)
        num = torch.einsum('bhqd,bhde->bhqe', pq, kv)
        den = torch.einsum('bhqd,bhd->bhq', pq, z)[..., None] + 1e-06
        o = num / den
        return (lambda x, *d: x.permute(*d))(o, 0, 2, 1, 3).reshape(B, S, D) @ wo

    def _B_ref(x, w_in, w_sp, b_sp, w_out):
        B, S, D = x.shape
        F = w_in.shape[-1]
        Fh = F // 2
        z = _gelu(torch.einsum('bsd,df->bsf', x, w_in))
        z1 = z[..., :Fh].clone()
        z2 = _layernorm(z[..., Fh:], axis=-1)
        g = torch.einsum('ts,bsf->btf', w_sp, z2) + b_sp[None, :, None]
        return torch.einsum('bsf,fd->bsd', z1 * g, w_out)
    x = A_x
    xn = _layernorm(x, axis=-1)
    s = _A_ref(xn, A_wqkv, A_wo)
    g = _silu(_B_ref(xn, B_w_in, B_w_sp, B_b_sp, B_w_out))
    return x + s * g
```

```asm
; @launch grid=(256,1,1) block=(512,1,1) lds=163840
.amdgcn_target "amdgcn-amd-amdhsa--gfx950"
.text
.globl recurrent_scan__linear_attn_block__mixer_gmlp__prompt_kernel
.p2align 8
.type recurrent_scan__linear_attn_block__mixer_gmlp__prompt_kernel,@function
recurrent_scan__linear_attn_block__mixer_gmlp__prompt_kernel:
    s_cmp_ge_u32 s2, 256
    s_cbranch_scc1 L_end
    s_load_dwordx2 s[4:5], s[0:1], 0
    s_load_dwordx2 s[20:21], s[0:1], 8
    s_load_dwordx2 s[22:23], s[0:1], 32
    s_load_dwordx2 s[12:13], s[0:1], 80
    s_load_dwordx2 s[88:89], s[0:1], 40
    s_load_dwordx2 s[90:91], s[0:1], 48
    s_load_dwordx2 s[92:93], s[0:1], 16
    s_load_dwordx2 s[94:95], s[0:1], 56
    s_load_dwordx2 s[96:97], s[0:1], 64
    v_lshrrev_b32 v96, 6, v0
    v_and_b32 v8, 63, v0
    v_readfirstlane_b32 s24, v96
    s_lshr_b32 s32, s2, 3
    s_lshr_b32 s31, s2, 1
    s_and_b32 s31, s31, 3
    s_and_b32 s34, s2, 1
    s_lshl_b32 s27, s34, 3
    s_and_b32 s33, s32, 7
    s_add_u32 s27, s27, s33
    s_lshr_b32 s33, s32, 3
    s_lshl_b32 s28, s33, 2
    s_add_u32 s28, s28, s31
    s_lshl_b32 s78, s31, 3
    s_and_b32 s33, s32, 7
    s_add_u32 s78, s78, s33
    s_lshl_b32 s79, s34, 2
    s_lshr_b32 s33, s32, 3
    s_add_u32 s79, s79, s33
    s_and_b32 s25, s24, 3
    s_lshr_b32 s26, s24, 2
    s_mov_b32 s62, 1572864
    s_mov_b32 s63, 1835008
    s_cmp_lt_u32 s28, 8
    s_cbranch_scc1 L_tX
    s_sub_u32 s31, s28, 8
    s_lshr_b32 s31, s31, 1
    s_add_u32 s31, s31, 10
    s_lshl_b32 s43, s31, 7
    s_mov_b32 s47, 1
    s_mov_b32 s51, 0
    s_mov_b32 s55, s31
    s_sub_u32 s37, 4, s26
    s_cmp_lt_u32 s28, 14
    s_cbranch_scc1 L_tY
    s_sub_u32 s31, s28, 14
    s_lshl_b32 s31, s31, 1
    s_add_u32 s31, s31, 6
    s_lshl_b32 s40, s31, 7
    s_mov_b32 s44, 1
    s_mov_b32 s48, 0
    s_mov_b32 s52, s31
    s_add_u32 s31, s31, 1
    s_lshl_b32 s42, s31, 7
    s_mov_b32 s46, 1
    s_mov_b32 s50, 0
    s_mov_b32 s54, s31
    s_sub_u32 s31, s28, 8
    s_lshl_b32 s41, s31, 7
    s_mov_b32 s45, 0
    s_mov_b32 s49, 2
    s_mov_b32 s53, s31
    s_branch L_tdone
L_tY:
    s_lshl_b32 s40, s28, 7
    s_add_u32 s40, s40, 1792
    s_mov_b32 s44, 1
    s_mov_b32 s48, 1
    s_mov_b32 s52, s28
    s_sub_u32 s31, s28, 8
    s_lshl_b32 s41, s31, 7
    s_mov_b32 s45, 0
    s_mov_b32 s49, 2
    s_mov_b32 s53, s31
    s_lshl_b32 s42, s31, 7
    s_mov_b32 s46, 1
    s_mov_b32 s50, 0
    s_mov_b32 s54, s31
    s_branch L_tdone
L_tX:
    s_lshl_b32 s40, s28, 7
    s_add_u32 s40, s40, 1792
    s_mov_b32 s44, 1
    s_mov_b32 s48, 1
    s_mov_b32 s52, s28
    s_lshl_b32 s31, s28, 7
    s_add_u32 s41, s31, 1024
    s_mov_b32 s45, 0
    s_mov_b32 s49, 3
    s_mov_b32 s53, s28
    s_add_u32 s42, s31, 2048
    s_mov_b32 s46, 0
    s_mov_b32 s50, 4
    s_mov_b32 s54, s28
    s_mov_b32 s43, s42
    s_mov_b32 s47, 0
    s_mov_b32 s51, 4
    s_mov_b32 s55, s28
    s_mov_b32 s37, 3
L_tdone:
    s_waitcnt lgkmcnt(0)
    s_and_b32 s13, s13, 0xffff
    s_mov_b32 s14, 268435456
    s_mov_b32 s15, 0x20000
    v_mov_b32 v14, 0
    s_mov_b32 s31, 16384
    buffer_load_dword v14, v14, s[12:15], s31 offen sc1
    s_and_b32 s5, s5, 0xffff
    s_mov_b32 s6, 2097152
    s_mov_b32 s7, 0x20000
L_tch_c:
    s_getpc_b64 s[16:17]
L_pc0:
    s_and_b32 s17, s17, 0xffff
    s_mov_b32 s18, L_codeend-L_pc0
    s_mov_b32 s19, 0x20000
    v_lshlrev_b32 v96, 7, v8
    s_lshr_b32 s31, s2, 3
    s_lshl_b32 s31, s31, 10
    s_cmp_lg_u32 s24, 0
    s_cselect_b32 s31, 2130706432, s31
    s_mov_b64 exec, 0xff
    buffer_load_dword v35, v96, s[16:19], s31 offen
    s_mov_b64 exec, -1
    v_lshlrev_b32 v1, 4, v8
    v_lshrrev_b32 v96, 3, v8
    v_and_b32 v97, 7, v8
    v_lshrrev_b32 v98, 1, v96
    v_xor_b32 v99, v97, v98
    v_lshlrev_b32 v99, 4, v99
    v_lshl_add_u32 v44, v96, 10, v99
    v_xor_b32 v45, 64, v44
    v_and_b32 v98, 1, v98
    v_lshlrev_b32 v98, 2, v98
    v_xor_b32 v98, v97, v98
    v_lshlrev_b32 v98, 4, v98
    v_mul_u32_u24 v99, 3072, v96
    v_add_u32 v5, v99, v98
    v_mul_u32_u24 v99, 3584, v96
    v_add_u32 v6, v99, v98
    s_mov_b32 s30, 0x3f803f80
    s_lshl_b32 s38, s27, 2
    s_add_u32 s38, s38, s25
    s_lshl_b32 s35, s27, 17
    s_lshl_b32 s31, s24, 14
    s_add_u32 s35, s35, s31
    s_lshr_b32 s31, s28, 2
    s_lshl_b32 s31, s31, 1
    s_add_u32 s31, s31, s27
    s_add_u32 s64, s31, 0
    s_and_b32 s64, s64, 7
    s_add_u32 s65, s31, 1
    s_and_b32 s65, s65, 7
    s_add_u32 s66, s31, 2
    s_and_b32 s66, s66, 7
    s_add_u32 s67, s31, 3
    s_and_b32 s67, s67, 7
    s_add_u32 s68, s31, 4
    s_and_b32 s68, s68, 7
    s_add_u32 s69, s31, 5
    s_and_b32 s69, s69, 7
    s_add_u32 s70, s31, 6
    s_and_b32 s70, s70, 7
    s_add_u32 s71, s31, 7
    s_and_b32 s71, s71, 7
    s_lshl_b32 s74, s24, 10
    s_lshl_b32 s75, s24, 11
    s_cmp_eq_u32 s44, 0
    s_cselect_b32 s8, s20, s22
    s_cselect_b32 s9, s21, s23
    s_cselect_b32 s10, s62, s63
    s_mov_b32 s11, 0x20000
    s_cselect_b64 vcc, -1, 0
    v_cndmask_b32 v7, v6, v5, vcc
    s_lshl_b32 s59, s44, 9
    s_add_u32 s59, s59, 3072
    s_lshl_b32 s72, s59, 6
    s_mul_i32 s73, s59, s24
    s_lshl_b32 s73, s73, 3
    s_add_u32 s73, s73, s40
    s_lshl_b32 s31, s64, 7
    s_add_u32 m0, s75, 0
    s_add_u32 s31, s31, s35
    buffer_load_dwordx4 v44, s[4:7], s31 offen lds
    s_add_u32 m0, s75, 1024
    s_add_u32 s31, s31, 8192
    buffer_load_dwordx4 v45, s[4:7], s31 offen lds
    s_mul_i32 s31, s64, s72
    s_add_u32 m0, s74, 65536
    s_add_u32 s31, s31, s73
    buffer_load_dwordx4 v7, s[8:11], s31 offen lds
    s_lshr_b32 s34, s27, 2
    s_mov_b32 s33, s44
    s_mov_b32 s32, s40
    s_cmp_eq_u32 s34, 1
    s_cselect_b32 s33, s45, s33
    s_cselect_b32 s32, s41, s32
    s_cmp_eq_u32 s34, 2
    s_cselect_b32 s33, s46, s33
    s_cselect_b32 s32, s42, s32
    s_cmp_eq_u32 s34, 3
    s_cselect_b32 s33, s47, s33
    s_cselect_b32 s32, s43, s32
    s_cmp_eq_u32 s33, 0
    s_cselect_b32 s8, s20, s22
    s_cselect_b32 s9, s21, s23
    s_cselect_b32 s10, s62, s63
    s_mov_b32 s11, 0x20000
    s_cselect_b64 vcc, -1, 0
    v_cndmask_b32 v7, v6, v5, vcc
    s_lshl_b32 s59, s33, 9
    s_add_u32 s59, s59, 3072
    s_lshl_b32 s72, s59, 6
    s_mul_i32 s73, s59, s24
    s_lshl_b32 s73, s73, 3
    s_add_u32 s73, s73, s32
    s_mul_i32 s98, s33, 24
    s_lshr_b32 s31, s32, 7
    s_add_u32 s98, s98, s31
    s_lshl_b32 s98, s98, 2
    s_and_b32 s31, s27, 3
    s_add_u32 s98, s98, s31
    s_lshl_b32 s98, s98, 9
    s_add_u32 s98, s98, 65536
    s_lshl_b32 s31, s31, 7
    s_lshl_b32 s33, s24, 4
    s_add_u32 s31, s31, s33
    s_mul_i32 s31, s31, s59
    s_add_u32 s31, s31, s32
    s_add_u32 m0, s75, 98304
    s_lshl_b32 s33, s59, 3
    buffer_load_dwordx4 v7, s[8:11], s31 offen lds
    s_add_u32 m0, s75, 99328
    s_add_u32 s31, s31, s33
    buffer_load_dwordx4 v7, s[8:11], s31 offen lds
    s_lshl_b32 s99, s27, 7
    s_lshl_b32 s31, s28, 3
    s_add_u32 s99, s99, s31
    s_add_u32 s99, s99, s24
    s_lshl_b32 s31, s99, 10
    buffer_load_dwordx4 v[72:75], v1, s[4:7], s31 offen
    s_cmp_eq_u32 s44, 0
    s_cselect_b32 s8, s20, s22
    s_cselect_b32 s9, s21, s23
    s_cselect_b32 s10, s62, s63
    s_mov_b32 s11, 0x20000
    s_cselect_b64 vcc, -1, 0
    v_cndmask_b32 v7, v6, v5, vcc
    s_lshl_b32 s59, s44, 9
    s_add_u32 s59, s59, 3072
    s_lshl_b32 s72, s59, 6
    s_mul_i32 s73, s59, s24
    s_lshl_b32 s73, s73, 3
    s_add_u32 s73, s73, s40
    s_lshl_b32 s31, s65, 7
    s_add_u32 m0, s75, 16384
    s_add_u32 s31, s31, s35
    buffer_load_dwordx4 v44, s[4:7], s31 offen lds
    s_add_u32 m0, s75, 17408
    s_add_u32 s31, s31, 8192
    buffer_load_dwordx4 v45, s[4:7], s31 offen lds
    s_mul_i32 s31, s65, s72
    s_add_u32 m0, s74, 73728
    s_add_u32 s31, s31, s73
    buffer_load_dwordx4 v7, s[8:11], s31 offen lds
    s_lshl_b32 s31, s66, 7
    s_add_u32 m0, s75, 32768
    s_add_u32 s31, s31, s35
    buffer_load_dwordx4 v44, s[4:7], s31 offen lds
    s_add_u32 m0, s75, 33792
    s_add_u32 s31, s31, 8192
    buffer_load_dwordx4 v45, s[4:7], s31 offen lds
    s_mul_i32 s31, s66, s72
    s_add_u32 m0, s74, 81920
    s_add_u32 s31, s31, s73
    buffer_load_dwordx4 v7, s[8:11], s31 offen lds
    v_and_b32 v100, 31, v8
    v_lshrrev_b32 v101, 5, v8
    v_lshrrev_b32 v102, 1, v100
    v_and_b32 v102, 7, v102
    v_xor_b32 v103, v101, v102
    v_lshlrev_b32 v103, 4, v103
    s_lshl_b32 s31, s25, 12
    v_lshl_add_u32 v104, v100, 7, v103
    v_add_u32 v36, s31, v104
    v_xor_b32 v37, 32, v36
    v_xor_b32 v38, 64, v36
    v_xor_b32 v39, 96, v36
    v_lshrrev_b32 v100, 2, v8
    v_and_b32 v100, 3, v100
    v_lshrrev_b32 v101, 5, v8
    v_lshl_add_u32 v102, v101, 3, v100
    v_lshrrev_b32 v103, 4, v8
    v_and_b32 v103, 1, v103
    v_lshrrev_b32 v104, 1, v8
    v_and_b32 v104, 1, v104
    v_lshl_add_u32 v104, v103, 1, v104
    v_lshrrev_b32 v105, 1, v100
    v_lshlrev_b32 v105, 2, v105
    v_xor_b32 v104, v104, v105
    v_lshlrev_b32 v104, 4, v104
    v_lshl_add_u32 v104, v102, 7, v104
    v_and_b32 v105, 1, v8
    v_lshl_add_u32 v4, v105, 3, v104
    v_lshrrev_b32 v100, 4, v8
    v_and_b32 v101, 1, v100
    v_lshlrev_b32 v101, 1, v101
    v_lshrrev_b32 v100, 1, v100
    v_or_b32 v100, v100, v101
    v_and_b32 v101, 15, v8
    v_lshl_add_u32 v100, v100, 4, v101
    v_lshlrev_b32 v2, 4, v100
    v_lshrrev_b32 v100, 4, v8
    v_and_b32 v100, 1, v100
    v_lshlrev_b32 v100, 16, v100
    v_lshrrev_b32 v101, 5, v8
    v_and_b32 v102, 15, v8
    v_lshl_add_u32 v101, v101, 4, v102
    v_lshl_add_u32 v3, v101, 4, v100
    v_and_b32 v100, 15, v8
    v_lshrrev_b32 v101, 2, v100
    v_and_b32 v101, 1, v101
    v_lshrrev_b32 v102, 5, v8
    v_and_b32 v103, 3, v100
    v_lshrrev_b32 v104, 3, v100
    v_lshl_add_u32 v103, v104, 2, v103
    v_and_b32 v104, 1, v103
    v_lshlrev_b32 v104, 4, v104
    v_mov_b32 v105, 0x3f80
    v_lshlrev_b32 v105, v104, v105
    v_lshrrev_b32 v103, 1, v103
    v_cmp_eq_u32 vcc, v101, v102
    s_nop 1
    v_cndmask_b32 v105, 0, v105, vcc
    v_lshrrev_b32 v106, 4, v8
    v_and_b32 v106, 1, v106
    v_lshl_add_u32 v106, v106, 2, v103
    v_cmp_eq_u32 vcc, 0, v106
    s_nop 1
    v_cndmask_b32 v24, 0, v105, vcc
    v_cmp_eq_u32 vcc, 1, v106
    s_nop 1
    v_cndmask_b32 v25, 0, v105, vcc
    v_cmp_eq_u32 vcc, 2, v106
    s_nop 1
    v_cndmask_b32 v26, 0, v105, vcc
    v_cmp_eq_u32 vcc, 3, v106
    s_nop 1
    v_cndmask_b32 v27, 0, v105, vcc
    v_cmp_eq_u32 vcc, 4, v106
    s_nop 1
    v_cndmask_b32 v28, 0, v105, vcc
    v_cmp_eq_u32 vcc, 5, v106
    s_nop 1
    v_cndmask_b32 v29, 0, v105, vcc
    v_cmp_eq_u32 vcc, 6, v106
    s_nop 1
    v_cndmask_b32 v30, 0, v105, vcc
    v_cmp_eq_u32 vcc, 7, v106
    s_nop 1
    v_cndmask_b32 v31, 0, v105, vcc
    v_mov_b32 v18, 0
    v_mov_b32 v19, 0
    v_mov_b32 v22, 0
    v_mov_b32 v23, 0
    s_lshl_b32 s31, s26, 6
    v_xor_b32 v32, s31, v4
    v_add_u32 v32, 65536, v32
    s_waitcnt vmcnt(6) lgkmcnt(0)
    s_barrier
    ds_read_b128 v[128:131], v36
    ds_read_b64_tr_b16 v[80:81], v32 offset:0
    ds_read_b64_tr_b16 v[82:83], v32 offset:512
    ds_read_b128 v[132:135], v37
    ds_read_b64_tr_b16 v[84:85], v32 offset:2048
    ds_read_b64_tr_b16 v[86:87], v32 offset:2560
    ds_read_b128 v[136:139], v38
    ds_read_b64_tr_b16 v[88:89], v32 offset:4096
    ds_read_b64_tr_b16 v[90:91], v32 offset:4608
    ds_read_b128 v[140:143], v39
    ds_read_b64_tr_b16 v[92:93], v32 offset:6144
    ds_read_b64_tr_b16 v[94:95], v32 offset:6656
    s_lshl_b32 s31, s67, 7
    s_add_u32 m0, s75, 49152
    s_add_u32 s31, s31, s35
    buffer_load_dwordx4 v44, s[4:7], s31 offen lds
    s_add_u32 m0, s75, 50176
    s_add_u32 s31, s31, 8192
    buffer_load_dwordx4 v45, s[4:7], s31 offen lds
    s_mul_i32 s31, s67, s72
    s_add_u32 m0, s74, 90112
    s_add_u32 s31, s31, s73
    buffer_load_dwordx4 v7, s[8:11], s31 offen lds
    v_readfirstlane_b32 s29, v14
    s_nop 4
    s_add_u32 s29, s29, 1
    s_lshl_b32 s31, s26, 6
    v_xor_b32 v66, s31, v4
    s_lshl_b32 s31, s25, 12
    s_add_u32 s31, s31, 98304
    v_add_u32 v66, s31, v66
    ds_read_b64_tr_b16 v[48:49], v66 offset:0
    ds_read_b64_tr_b16 v[50:51], v66 offset:512
    ds_read_b64_tr_b16 v[52:53], v66 offset:2048
    ds_read_b64_tr_b16 v[54:55], v66 offset:2560
    v_mov_b32 v64, 0
    v_mov_b32 v65, 0
    v_dot2c_f32_bf16 v64, s30, v72
    v_dot2c_f32_bf16 v65, v72, v72
    v_dot2c_f32_bf16 v64, s30, v73
    v_dot2c_f32_bf16 v65, v73, v73
    v_dot2c_f32_bf16 v64, s30, v74
    v_dot2c_f32_bf16 v65, v74, v74
    v_dot2c_f32_bf16 v64, s30, v75
    v_dot2c_f32_bf16 v65, v75, v75
    s_nop 1
    v_add_f32_dpp v64, v64, v64 row_shr:1 row_mask:0xf bank_mask:0xf bound_ctrl:0
    v_add_f32_dpp v65, v65, v65 row_shr:1 row_mask:0xf bank_mask:0xf bound_ctrl:0
    s_nop 0
    v_add_f32_dpp v64, v64, v64 row_shr:2 row_mask:0xf bank_mask:0xf bound_ctrl:0
    v_add_f32_dpp v65, v65, v65 row_shr:2 row_mask:0xf bank_mask:0xf bound_ctrl:0
    s_nop 0
    v_add_f32_dpp v64, v64, v64 row_shr:4 row_mask:0xf bank_mask:0xf bound_ctrl:0
    v_add_f32_dpp v65, v65, v65 row_shr:4 row_mask:0xf bank_mask:0xf bound_ctrl:0
    s_nop 0
    v_add_f32_dpp v64, v64, v64 row_shr:8 row_mask:0xf bank_mask:0xf bound_ctrl:0
    v_add_f32_dpp v65, v65, v65 row_shr:8 row_mask:0xf bank_mask:0xf bound_ctrl:0
    s_nop 0
    v_add_f32_dpp v64, v64, v64 row_bcast:15 row_mask:0xa bank_mask:0xf
    v_add_f32_dpp v65, v65, v65 row_bcast:15 row_mask:0xa bank_mask:0xf
    s_nop 0
    v_add_f32_dpp v64, v64, v64 row_bcast:31 row_mask:0xc bank_mask:0xf
    v_add_f32_dpp v65, v65, v65 row_bcast:31 row_mask:0xc bank_mask:0xf
    v_mul_f32 v64, 0x3b000000, v64
    v_mul_f32 v65, 0x3b000000, v65
    v_fma_f32 v65, -v64, v64, v65
    v_max_f32 v65, 0, v65
    v_add_f32 v65, 0x3727c5ac, v65
    v_rsq_f32 v69, v65
    v_sub_f32 v68, 0, v64
    v_mov_b32 v70, s29
    v_mov_b32 v71, s29
    s_lshl_b32 s31, s99, 4
    s_add_u32 s31, s31, 32768
    v_mov_b32 v67, 0
    v_cmp_eq_u32 vcc, 63, v8
    s_nop 3
    s_and_saveexec_b64 s[60:61], vcc
    buffer_store_dwordx4 v[68:71], v67, s[12:15], s31 offen sc1
    s_mov_b64 exec, s[60:61]
    v_mov_b32 v64, 0
    v_mov_b32 v65, 0
    s_waitcnt lgkmcnt(0)
    v_dot2c_f32_bf16 v64, s30, v48
    v_dot2c_f32_bf16 v65, s30, v49
    v_dot2c_f32_bf16 v64, s30, v50
    v_dot2c_f32_bf16 v65, s30, v51
    v_dot2c_f32_bf16 v64, s30, v52
    v_dot2c_f32_bf16 v65, s30, v53
    v_dot2c_f32_bf16 v64, s30, v54
    v_dot2c_f32_bf16 v65, s30, v55
    s_nop 2
    v_add_f32 v64, v64, v65
    v_and_b32 v66, 31, v8
    v_lshlrev_b32 v66, 5, v66
    s_lshl_b32 s31, s26, 10
    s_add_u32 s31, s31, 114688
    v_add_u32 v15, s31, v66
    v_lshrrev_b32 v67, 5, v8
    v_lshl_add_u32 v66, v67, 2, v15
    s_lshl_b32 s31, s25, 3
    v_add_u32 v66, s31, v66
    ds_write_b32 v66, v64
    s_waitcnt vmcnt(7) lgkmcnt(0)
    s_barrier
    v_add_u32 v36, 16384, v36
    v_add_u32 v37, 16384, v37
    v_add_u32 v38, 16384, v38
    v_add_u32 v39, 16384, v39
    ds_read_b128 v[144:147], v36
    ds_read_b64_tr_b16 v[96:97], v32 offset:8192
    ds_read_b64_tr_b16 v[98:99], v32 offset:8704
    ds_read_b128 v[148:151], v37
    ds_read_b64_tr_b16 v[100:101], v32 offset:10240
    ds_read_b64_tr_b16 v[102:103], v32 offset:10752
    ds_read_b128 v[152:155], v38
    ds_read_b64_tr_b16 v[104:105], v32 offset:12288
    ds_read_b64_tr_b16 v[106:107], v32 offset:12800
    ds_read_b128 v[156:159], v39
    ds_read_b64_tr_b16 v[108:109], v32 offset:14336
    ds_read_b64_tr_b16 v[110:111], v32 offset:14848
    v_mfma_f32_32x32x16_bf16 v[112:127], v[80:83], v[128:131], 0
    v_mfma_f32_32x32x16_bf16 v[112:127], v[84:87], v[132:135], v[112:127]
    v_mfma_f32_32x32x16_bf16 v[112:127], v[88:91], v[136:139], v[112:127]
    v_mfma_f32_32x32x16_bf16 v[112:127], v[92:95], v[140:143], v[112:127]
    s_lshl_b32 s31, s68, 7
    s_add_u32 m0, s75, 0
    s_add_u32 s31, s31, s35
    buffer_load_dwordx4 v44, s[4:7], s31 offen lds
    s_add_u32 m0, s75, 1024
    s_add_u32 s31, s31, 8192
    buffer_load_dwordx4 v45, s[4:7], s31 offen lds
    s_mul_i32 s31, s68, s72
    s_add_u32 m0, s74, 65536
    s_add_u32 s31, s31, s73
    buffer_load_dwordx4 v7, s[8:11], s31 offen lds
    s_waitcnt vmcnt(7) lgkmcnt(0)
    s_barrier
    v_add_u32 v36, 16384, v36
    v_add_u32 v37, 16384, v37
    v_add_u32 v38, 16384, v38
    v_add_u32 v39, 16384, v39
    ds_read_b128 v[160:163], v36
    ds_read_b64_tr_b16 v[80:81], v32 offset:16384
    ds_read_b64_tr_b16 v[82:83], v32 offset:16896
    ds_read_b128 v[164:167], v37
    ds_read_b64_tr_b16 v[84:85], v32 offset:18432
    ds_read_b64_tr_b16 v[86:87], v32 offset:18944
    ds_read_b128 v[168:171], v38
    ds_read_b64_tr_b16 v[88:89], v32 offset:20480
    ds_read_b64_tr_b16 v[90:91], v32 offset:20992
    ds_read_b128 v[172:175], v39
    ds_read_b64_tr_b16 v[92:93], v32 offset:22528
    ds_read_b64_tr_b16 v[94:95], v32 offset:23040
    v_mfma_f32_32x32x16_bf16 v[112:127], v[96:99], v[144:147], v[112:127]
    v_mfma_f32_32x32x16_bf16 v[112:127], v[100:103], v[148:151], v[112:127]
    v_mfma_f32_32x32x16_bf16 v[112:127], v[104:107], v[152:155], v[112:127]
    v_mfma_f32_32x32x16_bf16 v[112:127], v[108:111], v[156:159], v[112:127]
    s_lshl_b32 s31, s69, 7
    s_add_u32 m0, s75, 16384
    s_add_u32 s31, s31, s35
    buffer_load_dwordx4 v44, s[4:7], s31 offen lds
    s_add_u32 m0, s75, 17408
    s_add_u32 s31, s31, 8192
    buffer_load_dwordx4 v45, s[4:7], s31 offen lds
    s_mul_i32 s31, s69, s72
    s_add_u32 m0, s74, 73728
    s_add_u32 s31, s31, s73
    buffer_load_dwordx4 v7, s[8:11], s31 offen lds
    ds_read_b128 v[48:51], v15
    ds_read_b128 v[52:55], v15 offset:16
    s_lshl_b32 s32, s26, 8
    s_add_u32 s31, s98, s32
    s_cmp_lg_u32 s25, 0
    s_cselect_b32 s31, 2130706432, s31
    v_and_b32 v70, 31, v8
    v_lshlrev_b32 v70, 3, v70
    s_waitcnt lgkmcnt(0)
    v_add_f32 v48, v48, v49
    v_add_f32 v50, v50, v51
    v_add_f32 v52, v52, v53
    v_add_f32 v54, v54, v55
    v_add_f32 v48, v48, v50
    v_add_f32 v52, v52, v54
    v_add_f32 v48, v48, v52
    v_mov_b32 v49, s29
    v_cmp_gt_u32 vcc, 32, v8
    s_nop 3
    s_and_saveexec_b64 s[60:61], vcc
    buffer_store_dwordx2 v[48:49], v70, s[12:15], s31 offen sc1
    s_mov_b64 exec, s[60:61]
    s_waitcnt vmcnt(8) lgkmcnt(0)
    s_barrier
    v_add_u32 v36, 16384, v36
    v_add_u32 v37, 16384, v37
    v_add_u32 v38, 16384, v38
    v_add_u32 v39, 16384, v39
    ds_read_b128 v[176:179], v36
    ds_read_b64_tr_b16 v[96:97], v32 offset:24576
    ds_read_b64_tr_b16 v[98:99], v32 offset:25088
    ds_read_b128 v[180:183], v37
    ds_read_b64_tr_b16 v[100:101], v32 offset:26624
    ds_read_b64_tr_b16 v[102:103], v32 offset:27136
    ds_read_b128 v[184:187], v38
    ds_read_b64_tr_b16 v[104:105], v32 offset:28672
    ds_read_b64_tr_b16 v[106:107], v32 offset:29184
    ds_read_b128 v[188:191], v39
    ds_read_b64_tr_b16 v[108:109], v32 offset:30720
    ds_read_b64_tr_b16 v[110:111], v32 offset:31232
    v_mfma_f32_32x32x16_bf16 v[112:127], v[80:83], v[160:163], v[112:127]
    v_mfma_f32_32x32x16_bf16 v[112:127], v[84:87], v[164:167], v[112:127]
    v_mfma_f32_32x32x16_bf16 v[112:127], v[88:91], v[168:171], v[112:127]
    v_mfma_f32_32x32x16_bf16 v[112:127], v[92:95], v[172:175], v[112:127]
    s_lshl_b32 s31, s70, 7
    s_add_u32 m0, s75, 32768
    s_add_u32 s31, s31, s35
    buffer_load_dwordx4 v44, s[4:7], s31 offen lds
    s_add_u32 m0, s75, 33792
    s_add_u32 s31, s31, 8192
    buffer_load_dwordx4 v45, s[4:7], s31 offen lds
    s_mul_i32 s31, s70, s72
    s_add_u32 m0, s74, 81920
    s_add_u32 s31, s31, s73
    buffer_load_dwordx4 v7, s[8:11], s31 offen lds
    v_mov_b32 v72, -1
    v_mov_b32 v73, -1
    v_mov_b32 v74, -1
    v_mov_b32 v75, -1
    s_lshl_b32 s31, s28, 2
    s_lshr_b32 s32, s24, 1
    s_add_u32 s31, s31, s32
    s_lshl_b32 s31, s31, 6
    s_lshl_b32 s32, s27, 2
    s_add_u32 s31, s31, s32
    s_and_b32 s32, s24, 1
    s_lshl_b32 s32, s32, 1
    s_add_u32 s31, s31, s32
    s_lshl_b32 s31, s31, 10
    s_add_u32 s31, s31, 2097152
    s_cmp_ge_u32 s28, 14
    s_cselect_b32 s31, 2130706432, s31
    buffer_store_dwordx4 v[72:75], v1, s[12:15], s31 offen sc1
    buffer_store_dwordx4 v[72:75], v1, s[12:15], s31 offen offset:1024 sc1
    s_lshl_b32 s31, s27, 4
    s_add_u32 s31, s31, s28
    s_lshl_b32 s31, s31, 10
    s_add_u32 s31, s31, 196608
    s_cmp_lg_u32 s24, 0
    s_cselect_b32 s31, 2130706432, s31
    s_cselect_b64 exec, 1, -1
    buffer_store_dwordx4 v[72:75], v1, s[12:15], s31 offen sc1
    s_mov_b64 exec, -1
    s_waitcnt vmcnt(10) lgkmcnt(0)
    s_barrier
    v_subrev_u32 v36, 49152, v36
    v_subrev_u32 v37, 49152, v37
    v_subrev_u32 v38, 49152, v38
    v_subrev_u32 v39, 49152, v39
    ds_read_b128 v[192:195], v36
    ds_read_b64_tr_b16 v[80:81], v32 offset:0
    ds_read_b64_tr_b16 v[82:83], v32 offset:512
    ds_read_b128 v[196:199], v37
    ds_read_b64_tr_b16 v[84:85], v32 offset:2048
    ds_read_b64_tr_b16 v[86:87], v32 offset:2560
    ds_read_b128 v[200:203], v38
    ds_read_b64_tr_b16 v[88:89], v32 offset:4096
    ds_read_b64_tr_b16 v[90:91], v32 offset:4608
    ds_read_b128 v[204:207], v39
    ds_read_b64_tr_b16 v[92:93], v32 offset:6144
    ds_read_b64_tr_b16 v[94:95], v32 offset:6656
    v_mfma_f32_32x32x16_bf16 v[112:127], v[96:99], v[176:179], v[112:127]
    v_mfma_f32_32x32x16_bf16 v[112:127], v[100:103], v[180:183], v[112:127]
    v_mfma_f32_32x32x16_bf16 v[112:127], v[104:107], v[184:187], v[112:127]
    v_mfma_f32_32x32x16_bf16 v[112:127], v[108:111], v[188:191], v[112:127]
    s_lshl_b32 s31, s71, 7
    s_add_u32 m0, s75, 49152
    s_add_u32 s31, s31, s35
    buffer_load_dwordx4 v44, s[4:7], s31 offen lds
    s_add_u32 m0, s75, 50176
    s_add_u32 s31, s31, 8192
    buffer_load_dwordx4 v45, s[4:7], s31 offen lds
    s_mul_i32 s31, s71, s72
    s_add_u32 m0, s74, 90112
    s_add_u32 s31, s31, s73
    buffer_load_dwordx4 v7, s[8:11], s31 offen lds
    s_waitcnt vmcnt(10) lgkmcnt(0)
    s_barrier
    v_add_u32 v36, 16384, v36
    v_add_u32 v37, 16384, v37
    v_add_u32 v38, 16384, v38
    v_add_u32 v39, 16384, v39
    ds_read_b128 v[208:211], v36
    ds_read_b64_tr_b16 v[96:97], v32 offset:8192
    ds_read_b64_tr_b16 v[98:99], v32 offset:8704
    ds_read_b128 v[212:215], v37
    ds_read_b64_tr_b16 v[100:101], v32 offset:10240
    ds_read_b64_tr_b16 v[102:103], v32 offset:10752
    ds_read_b128 v[216:219], v38
    ds_read_b64_tr_b16 v[104:105], v32 offset:12288
    ds_read_b64_tr_b16 v[106:107], v32 offset:12800
    ds_read_b128 v[220:223], v39
    ds_read_b64_tr_b16 v[108:109], v32 offset:14336
    ds_read_b64_tr_b16 v[110:111], v32 offset:14848
    v_mfma_f32_32x32x16_bf16 v[112:127], v[80:83], v[192:195], v[112:127]
    v_mfma_f32_32x32x16_bf16 v[112:127], v[84:87], v[196:199], v[112:127]
    v_mfma_f32_32x32x16_bf16 v[112:127], v[88:91], v[200:203], v[112:127]
    v_mfma_f32_32x32x16_bf16 v[112:127], v[92:95], v[204:207], v[112:127]
    s_lshr_b32 s34, s24, 1
    s_mov_b32 s33, s44
    s_mov_b32 s32, s40
    s_cmp_eq_u32 s34, 1
    s_cselect_b32 s33, s45, s33
    s_cselect_b32 s32, s41, s32
    s_cmp_eq_u32 s34, 2
    s_cselect_b32 s33, s46, s33
    s_cselect_b32 s32, s42, s32
    s_cmp_eq_u32 s34, 3
    s_cselect_b32 s33, s47, s33
    s_cselect_b32 s32, s43, s32
    s_mul_i32 s31, s33, 24
    s_lshr_b32 s32, s32, 7
    s_add_u32 s31, s31, s32
    s_lshl_b32 s31, s31, 11
    s_and_b32 s32, s24, 1
    s_lshl_b32 s32, s32, 10
    s_add_u32 s31, s31, s32
    s_add_u32 s31, s31, 65536
    s_add_u32 m0, s74, 0
    s_lshl_b32 s32, s27, 11
    s_add_u32 s32, s32, s74
    s_add_u32 s32, s32, 32768
    buffer_load_dwordx4 v1, s[12:15], s31 offen sc1 lds
    s_add_u32 m0, s74, 8192
    s_cmp_ge_u32 s24, 2
    s_cselect_b32 s32, 2130706432, s32
    s_cselect_b64 exec, 1, -1
    buffer_load_dwordx4 v1, s[12:15], s32 offen sc1 lds
    s_mov_b64 exec, -1
    s_cmp_eq_u32 s45, 0
    s_cselect_b32 s8, s20, s22
    s_cselect_b32 s9, s21, s23
    s_cselect_b32 s10, s62, s63
    s_mov_b32 s11, 0x20000
    s_cselect_b64 vcc, -1, 0
    v_cndmask_b32 v7, v6, v5, vcc
    s_lshl_b32 s59, s45, 9
    s_add_u32 s59, s59, 3072
    s_lshl_b32 s72, s59, 6
    s_mul_i32 s73, s59, s24
    s_lshl_b32 s73, s73, 3
    s_add_u32 s73, s73, s41
    s_mul_i32 s31, s64, s72
    s_add_u32 m0, s74, 98304
    s_add_u32 s31, s31, s73
    buffer_load_dwordx4 v7, s[8:11], s31 offen lds
    s_mul_i32 s31, s65, s72
    s_add_u32 m0, s74, 106496
    s_add_u32 s31, s31, s73
    buffer_load_dwordx4 v7, s[8:11], s31 offen lds
    s_waitcnt vmcnt(10) lgkmcnt(0)
    s_barrier
    v_add_u32 v36, 16384, v36
    v_add_u32 v37, 16384, v37
    v_add_u32 v38, 16384, v38
    v_add_u32 v39, 16384, v39
    ds_read_b128 v[224:227], v36
    ds_read_b64_tr_b16 v[80:81], v32 offset:16384
    ds_read_b64_tr_b16 v[82:83], v32 offset:16896
    ds_read_b128 v[228:231], v37
    ds_read_b64_tr_b16 v[84:85], v32 offset:18432
    ds_read_b64_tr_b16 v[86:87], v32 offset:18944
    ds_read_b128 v[232:235], v38
    ds_read_b64_tr_b16 v[88:89], v32 offset:20480
    ds_read_b64_tr_b16 v[90:91], v32 offset:20992
    ds_read_b128 v[236:239], v39
    ds_read_b64_tr_b16 v[92:93], v32 offset:22528
    ds_read_b64_tr_b16 v[94:95], v32 offset:23040
    v_mfma_f32_32x32x16_bf16 v[112:127], v[96:99], v[208:211], v[112:127]
    v_mfma_f32_32x32x16_bf16 v[112:127], v[100:103], v[212:215], v[112:127]
    v_mfma_f32_32x32x16_bf16 v[112:127], v[104:107], v[216:219], v[112:127]
    v_mfma_f32_32x32x16_bf16 v[112:127], v[108:111], v[220:223], v[112:127]
    s_mul_i32 s31, s66, s72
    s_add_u32 m0, s74, 114688
    s_add_u32 s31, s31, s73
    buffer_load_dwordx4 v7, s[8:11], s31 offen lds
    s_mul_i32 s31, s67, s72
    s_add_u32 m0, s74, 122880
    s_add_u32 s31, s31, s73
    buffer_load_dwordx4 v7, s[8:11], s31 offen lds
    s_waitcnt vmcnt(4) lgkmcnt(0)
    s_barrier
    v_add_u32 v36, 16384, v36
    v_add_u32 v37, 16384, v37
    v_add_u32 v38, 16384, v38
    v_add_u32 v39, 16384, v39
    ds_read_b128 v[240:243], v36
    ds_read_b64_tr_b16 v[96:97], v32 offset:24576
    ds_read_b64_tr_b16 v[98:99], v32 offset:25088
    ds_read_b128 v[244:247], v37
    ds_read_b64_tr_b16 v[100:101], v32 offset:26624
    ds_read_b64_tr_b16 v[102:103], v32 offset:27136
    ds_read_b128 v[248:251], v38
    ds_read_b64_tr_b16 v[104:105], v32 offset:28672
    ds_read_b64_tr_b16 v[106:107], v32 offset:29184
    ds_read_b128 v[252:255], v39
    ds_read_b64_tr_b16 v[108:109], v32 offset:30720
    ds_read_b64_tr_b16 v[110:111], v32 offset:31232
    v_mfma_f32_32x32x16_bf16 v[112:127], v[80:83], v[224:227], v[112:127]
    v_mfma_f32_32x32x16_bf16 v[112:127], v[84:87], v[228:231], v[112:127]
    v_mfma_f32_32x32x16_bf16 v[112:127], v[88:91], v[232:235], v[112:127]
    v_mfma_f32_32x32x16_bf16 v[112:127], v[92:95], v[236:239], v[112:127]
    v_and_b32 v72, 31, v8
    v_lshlrev_b32 v73, 4, v72
    s_lshl_b32 s31, s25, 9
    s_add_u32 s31, s31, 8192
    v_add_u32 v73, s31, v73
    ds_read_b128 v[64:67], v73
    v_lshrrev_b32 v74, 5, v8
    v_lshlrev_b32 v74, 10, v74
    v_lshl_add_u32 v74, v72, 3, v74
    s_lshl_b32 s31, s26, 8
    v_add_u32 v75, s31, v74
    s_and_b32 s31, s28, 1
    s_lshl_b32 s31, s31, 8
    v_add_u32 v74, s31, v74
    ds_read_b64 v[48:49], v75 offset:0
    ds_read_b64 v[50:51], v75 offset:512
    ds_read_b64 v[52:53], v75 offset:2048
    ds_read_b64 v[54:55], v75 offset:2560
    ds_read_b64 v[56:57], v75 offset:4096
    ds_read_b64 v[58:59], v75 offset:4608
    ds_read_b64 v[60:61], v74 offset:6144
    ds_read_b64 v[62:63], v74 offset:6656
    s_waitcnt lgkmcnt(0)
    s_mov_b32 s80, 0
L_gr_chk:
    v_xor_b32 v72, s29, v66
    v_xor_b32 v73, s29, v67
    v_or_b32 v72, v72, v73
    v_xor_b32 v73, s29, v49
    v_or_b32 v72, v72, v73
    v_xor_b32 v73, s29, v51
    v_or_b32 v72, v72, v73
    v_xor_b32 v73, s29, v53
    v_or_b32 v72, v72, v73
    v_xor_b32 v73, s29, v55
    v_or_b32 v72, v72, v73
    v_xor_b32 v73, s29, v57
    v_or_b32 v72, v72, v73
    v_xor_b32 v73, s29, v59
    v_or_b32 v72, v72, v73
    v_xor_b32 v73, s29, v61
    v_or_b32 v72, v72, v73
    v_xor_b32 v73, s29, v63
    v_or_b32 v72, v72, v73
    v_cmp_ne_u32 vcc, 0, v72
    s_nop 3
    s_cbranch_vccz L_gr_ok
    s_add_u32 s80, s80, 1
    s_cmp_gt_u32 s80, 200000
    s_cbranch_scc1 L_gr_ok
    v_and_b32 v72, 31, v8
    v_lshlrev_b32 v73, 4, v72
    s_lshl_b32 s31, s38, 9
    s_add_u32 s31, s31, 32768
    buffer_load_dwordx4 v[64:67], v73, s[12:15], s31 offen sc1
    v_lshrrev_b32 v74, 5, v8
    v_lshlrev_b32 v74, 10, v74
    v_lshl_add_u32 v74, v72, 3, v74
    s_mul_i32 s31, s44, 24
    s_lshr_b32 s32, s40, 7
    s_add_u32 s31, s31, s32
    s_lshl_b32 s31, s31, 11
    s_lshl_b32 s32, s26, 8
    s_add_u32 s31, s31, s32
    s_add_u32 s31, s31, 65536
    buffer_load_dwordx2 v[48:49], v74, s[12:15], s31 offen offset:0 sc1
    buffer_load_dwordx2 v[50:51], v74, s[12:15], s31 offen offset:512 sc1
    s_mul_i32 s31, s45, 24
    s_lshr_b32 s32, s41, 7
    s_add_u32 s31, s31, s32
    s_lshl_b32 s31, s31, 11
    s_lshl_b32 s32, s26, 8
    s_add_u32 s31, s31, s32
    s_add_u32 s31, s31, 65536
    buffer_load_dwordx2 v[52:53], v74, s[12:15], s31 offen offset:0 sc1
    buffer_load_dwordx2 v[54:55], v74, s[12:15], s31 offen offset:512 sc1
    s_mul_i32 s31, s46, 24
    s_lshr_b32 s32, s42, 7
    s_add_u32 s31, s31, s32
    s_lshl_b32 s31, s31, 11
    s_lshl_b32 s32, s26, 8
    s_add_u32 s31, s31, s32
    s_add_u32 s31, s31, 65536
    buffer_load_dwordx2 v[56:57], v74, s[12:15], s31 offen offset:0 sc1
    buffer_load_dwordx2 v[58:59], v74, s[12:15], s31 offen offset:512 sc1
    s_mul_i32 s31, s47, 24
    s_lshr_b32 s32, s43, 7
    s_add_u32 s31, s31, s32
    s_lshl_b32 s31, s31, 11
    s_and_b32 s32, s28, 1
    s_lshl_b32 s32, s32, 8
    s_add_u32 s31, s31, s32
    s_add_u32 s31, s31, 65536
    buffer_load_dwordx2 v[60:61], v74, s[12:15], s31 offen offset:0 sc1
    buffer_load_dwordx2 v[62:63], v74, s[12:15], s31 offen offset:512 sc1
    s_waitcnt vmcnt(0)
    s_branch L_gr_chk
L_gr_ok:
    v_mov_b32 v13, v65
    v_rcp_f32 v12, v65
    v_mul_f32 v11, 0xc0135761, v13
    v_mul_f32 v72, v13, v13
    v_mul_f32 v72, v72, v13
    v_mul_f32 v10, 0xbdd2d3e8, v72
    v_mul_f32 v14, 0x3fb8aa3b, v13
    v_cmp_gt_u32 vcc, 32, v8
    s_nop 1
    v_cndmask_b32 v72, 0, v64, vcc
    v_cvt_pk_bf16_f32 v73, v72, v72
    v_lshlrev_b32 v73, 16, v73
    v_sub_f32 v74, v72, v73
    v_cvt_pk_bf16_f32 v16, v72, v74
    v_cvt_pk_bf16_f32 v17, v72, 0
    v_add_f32 v72, v48, v50
    v_mov_b32 v73, v72
    s_nop 1
    v_permlane32_swap_b32 v72, v73
    v_add_f32 v72, v72, v73
    v_cvt_pk_bf16_f32 v40, v72, v72
    v_lshlrev_b32 v73, 16, v40
    v_sub_f32 v73, v72, v73
    v_cvt_pk_bf16_f32 v41, v73, 0
    v_add_f32 v72, v52, v54
    v_mov_b32 v73, v72
    s_nop 1
    v_permlane32_swap_b32 v72, v73
    v_add_f32 v72, v72, v73
    v_cvt_pk_bf16_f32 v42, v72, v72
    v_lshlrev_b32 v73, 16, v42
    v_sub_f32 v73, v72, v73
    v_cvt_pk_bf16_f32 v43, v73, 0
    v_add_f32 v72, v56, v58
    v_mov_b32 v73, v72
    s_nop 1
    v_permlane32_swap_b32 v72, v73
    v_add_f32 v72, v72, v73
    v_cvt_pk_bf16_f32 v44, v72, v72
    v_lshlrev_b32 v73, 16, v44
    v_sub_f32 v73, v72, v73
    v_cvt_pk_bf16_f32 v45, v73, 0
    v_add_f32 v72, v60, v62
    v_mov_b32 v73, v72
    s_nop 1
    v_permlane32_swap_b32 v72, v73
    v_add_f32 v72, v72, v73
    v_cvt_pk_bf16_f32 v46, v72, v72
    v_lshlrev_b32 v73, 16, v46
    v_sub_f32 v73, v72, v73
    v_cvt_pk_bf16_f32 v47, v73, 0
    s_waitcnt lgkmcnt(0)
    v_mfma_f32_32x32x16_bf16 v[112:127], v[96:99], v[240:243], v[112:127]
    v_mfma_f32_32x32x16_bf16 v[112:127], v[100:103], v[244:247], v[112:127]
    v_mfma_f32_32x32x16_bf16 v[112:127], v[104:107], v[248:251], v[112:127]
    v_mfma_f32_32x32x16_bf16 v[112:127], v[108:111], v[252:255], v[112:127]
    v_mov_b32 v20, v40
    v_mov_b32 v21, v41
    s_nop 1
    v_mfma_f32_32x32x16_bf16 v[112:127], v[20:23], v[16:19], v[112:127]
    s_barrier
    s_mov_b32 s81, 0x358637bd
    s_mov_b32 s36, 1
    s_mov_b32 s58, 0
    s_mov_b32 s39, s26
    s_mov_b32 s82, s48
    s_mov_b32 s83, s52
    s_lshl_b32 s76, s26, 1
    s_mov_b32 s100, 0
    s_mov_b32 s101, 0
    s_mov_b32 s87, 0
    s_cmp_lt_u32 s28, 8
    s_cselect_b32 s77, 6, 7
    s_lshr_b32 s31, s2, 2
    s_lshl_b32 s31, s31, 7
    s_and_b32 s32, s2, 3
    s_lshl_b32 s32, s32, 2
    s_add_u32 s31, s31, s32
    s_add_u32 s31, s31, 0
    s_cmp_lg_u32 s24, 0
    s_cselect_b32 s31, 2130706432, s31
    v_mov_b32 v38, s29
    v_mov_b32 v39, 0
    s_mov_b64 s[60:61], exec
    s_mov_b64 exec, 1
    buffer_store_dword v38, v39, s[12:15], s31 offen sc1
    s_mov_b64 exec, s[60:61]
    s_cmp_eq_u32 s26, 1
    s_cbranch_scc0 L_A_hend
    s_cmp_eq_u32 s45, 0
    s_cselect_b32 s8, s20, s22
    s_cselect_b32 s9, s21, s23
    s_cselect_b32 s10, s62, s63
    s_mov_b32 s11, 0x20000
    s_cselect_b64 vcc, -1, 0
    v_cndmask_b32 v7, v6, v5, vcc
    s_lshl_b32 s59, s45, 9
    s_add_u32 s59, s59, 3072
    s_lshl_b32 s72, s59, 6
    s_mul_i32 s73, s59, s24
    s_lshl_b32 s73, s73, 3
    s_add_u32 s73, s73, s41
    s_lshl_b32 s31, s25, 4
    s_mul_i32 s73, s59, s31
    s_add_u32 s73, s73, s41
    s_lshl_b32 s98, s59, 3
    s_lshl_b32 s99, s25, 11
    s_mul_i32 s31, s68, s72
    s_add_u32 m0, s99, 131072
    s_add_u32 s31, s31, s73
    buffer_load_dwordx4 v7, s[8:11], s31 offen lds
    s_add_u32 m0, s99, 132096
    s_add_u32 s31, s31, s98
    buffer_load_dwordx4 v7, s[8:11], s31 offen lds
    s_mul_i32 s31, s69, s72
    s_add_u32 m0, s99, 139264
    s_add_u32 s31, s31, s73
    buffer_load_dwordx4 v7, s[8:11], s31 offen lds
    s_add_u32 m0, s99, 140288
    s_add_u32 s31, s31, s98
    buffer_load_dwordx4 v7, s[8:11], s31 offen lds
    s_mul_i32 s31, s70, s72
    s_add_u32 m0, s99, 147456
    s_add_u32 s31, s31, s73
    buffer_load_dwordx4 v7, s[8:11], s31 offen lds
    s_add_u32 m0, s99, 148480
    s_add_u32 s31, s31, s98
    buffer_load_dwordx4 v7, s[8:11], s31 offen lds
    s_mul_i32 s31, s71, s72
    s_add_u32 m0, s99, 155648
    s_add_u32 s31, s31, s73
    buffer_load_dwordx4 v7, s[8:11], s31 offen lds
    s_add_u32 m0, s99, 156672
    s_add_u32 s31, s31, s98
    buffer_load_dwordx4 v7, s[8:11], s31 offen lds
    s_cmp_eq_u32 s46, 0
    s_cselect_b32 s8, s20, s22
    s_cselect_b32 s9, s21, s23
    s_cselect_b32 s10, s62, s63
    s_mov_b32 s11, 0x20000
    s_cselect_b64 vcc, -1, 0
    v_cndmask_b32 v7, v6, v5, vcc
    s_lshl_b32 s59, s46, 9
    s_add_u32 s59, s59, 3072
    s_lshl_b32 s72, s59, 6
    s_mul_i32 s73, s59, s24
    s_lshl_b32 s73, s73, 3
    s_add_u32 s73, s73, s42
    s_lshl_b32 s31, s25, 4
    s_mul_i32 s73, s59, s31
    s_add_u32 s73, s73, s42
    s_lshl_b32 s98, s59, 3
    s_lshl_b32 s99, s25, 11
    s_mul_i32 s31, s64, s72
    s_add_u32 m0, s99, 0
    s_add_u32 s31, s31, s73
    buffer_load_dwordx4 v7, s[8:11], s31 offen lds
    s_add_u32 m0, s99, 1024
    s_add_u32 s31, s31, s98
    buffer_load_dwordx4 v7, s[8:11], s31 offen lds
    s_mul_i32 s31, s65, s72
    s_add_u32 m0, s99, 8192
    s_add_u32 s31, s31, s73
    buffer_load_dwordx4 v7, s[8:11], s31 offen lds
    s_add_u32 m0, s99, 9216
    s_add_u32 s31, s31, s98
    buffer_load_dwordx4 v7, s[8:11], s31 offen lds
    s_mul_i32 s31, s66, s72
    s_add_u32 m0, s99, 16384
    s_add_u32 s31, s31, s73
    buffer_load_dwordx4 v7, s[8:11], s31 offen lds
    s_add_u32 m0, s99, 17408
    s_add_u32 s31, s31, s98
    buffer_load_dwordx4 v7, s[8:11], s31 offen lds
    s_mul_i32 s31, s67, s72
    s_add_u32 m0, s99, 24576
    s_add_u32 s31, s31, s73
    buffer_load_dwordx4 v7, s[8:11], s31 offen lds
    s_add_u32 m0, s99, 25600
    s_add_u32 s31, s31, s98
    buffer_load_dwordx4 v7, s[8:11], s31 offen lds
    s_mul_i32 s31, s68, s72
    s_add_u32 m0, s99, 32768
    s_add_u32 s31, s31, s73
    buffer_load_dwordx4 v7, s[8:11], s31 offen lds
    s_add_u32 m0, s99, 33792
    s_add_u32 s31, s31, s98
    buffer_load_dwordx4 v7, s[8:11], s31 offen lds
    s_mul_i32 s31, s69, s72
    s_add_u32 m0, s99, 40960
    s_add_u32 s31, s31, s73
    buffer_load_dwordx4 v7, s[8:11], s31 offen lds
    s_add_u32 m0, s99, 41984
    s_add_u32 s31, s31, s98
    buffer_load_dwordx4 v7, s[8:11], s31 offen lds
    s_mul_i32 s31, s70, s72
    s_add_u32 m0, s99, 49152
    s_add_u32 s31, s31, s73
    buffer_load_dwordx4 v7, s[8:11], s31 offen lds
    s_add_u32 m0, s99, 50176
    s_add_u32 s31, s31, s98
    buffer_load_dwordx4 v7, s[8:11], s31 offen lds
    s_mul_i32 s31, s71, s72
    s_add_u32 m0, s99, 57344
    s_add_u32 s31, s31, s73
    buffer_load_dwordx4 v7, s[8:11], s31 offen lds
    s_add_u32 m0, s99, 58368
    s_add_u32 s31, s31, s98
    buffer_load_dwordx4 v7, s[8:11], s31 offen lds
    s_branch L_A_hend
L_A_loop:
    s_cmp_eq_u32 s36, 3
    s_cbranch_scc1 L_A_h3
    s_cmp_eq_u32 s36, 4
    s_cbranch_scc1 L_A_h4
    s_cmp_eq_u32 s36, 6
    s_cbranch_scc1 L_A_h6
    s_cmp_eq_u32 s36, 5
    s_cbranch_scc0 L_A_hend
    s_cmp_eq_u32 s24, 0
    s_cbranch_scc0 L_A_hend
    s_waitcnt vmcnt(0)
    s_mov_b32 s80, 0
L_fci_chk:
    v_xor_b32 v34, s29, v34
    v_xor_b32 v35, s29, v35
    v_xor_b32 v36, s29, v36
    v_xor_b32 v37, s29, v37
    v_or_b32 v34, v34, v35
    v_or3_b32 v34, v34, v36, v37
    v_cmp_ne_u32 vcc, 0, v34
    s_nop 3
    s_cbranch_vccz L_fci_ok
    s_add_u32 s80, s80, 1
    s_cmp_gt_u32 s80, 200000
    s_cbranch_scc1 L_fci_ok
    v_lshlrev_b32 v38, 7, v8
    s_mov_b32 s31, 0
    buffer_load_dwordx4 v[34:37], v38, s[12:15], s31 offen sc1
    s_waitcnt vmcnt(0)
    s_branch L_fci_chk
L_fci_ok:
    s_cmp_ge_u32 s28, 14
    s_cbranch_scc1 L_A_hend
    v_lshrrev_b32 v38, 4, v8
    v_lshlrev_b32 v38, 10, v38
    v_and_b32 v39, 15, v8
    v_lshl_add_u32 v38, v39, 4, v38
    s_lshl_b32 s31, s27, 14
    s_add_u32 s31, s31, 196608
    s_add_u32 s32, s31, 0
    s_mov_b32 m0, 67584
    s_nop 0
    buffer_load_dwordx4 v38, s[12:15], s32 offen sc1 lds
    s_add_u32 s32, s31, 4096
    s_mov_b32 m0, 68608
    s_nop 0
    buffer_load_dwordx4 v38, s[12:15], s32 offen sc1 lds
    s_add_u32 s32, s31, 8192
    s_mov_b32 m0, 69632
    s_nop 0
    buffer_load_dwordx4 v38, s[12:15], s32 offen sc1 lds
    s_add_u32 s32, s31, 12288
    s_mov_b32 m0, 70656
    s_mov_b32 exec_hi, 0
    buffer_load_dwordx4 v38, s[12:15], s32 offen sc1 lds
    s_mov_b64 exec, -1
    s_add_u32 s32, s31, 256
    s_mov_b32 m0, 71168
    s_nop 0
    buffer_load_dwordx4 v38, s[12:15], s32 offen sc1 lds
    s_add_u32 s32, s31, 4352
    s_mov_b32 m0, 72192
    s_nop 0
    buffer_load_dwordx4 v38, s[12:15], s32 offen sc1 lds
    s_add_u32 s32, s31, 8448
    s_mov_b32 m0, 73216
    s_nop 0
    buffer_load_dwordx4 v38, s[12:15], s32 offen sc1 lds
    s_add_u32 s32, s31, 12544
    s_mov_b32 m0, 74240
    s_mov_b32 exec_hi, 0
    buffer_load_dwordx4 v38, s[12:15], s32 offen sc1 lds
    s_mov_b64 exec, -1
    s_add_u32 s32, s31, 512
    s_mov_b32 m0, 74752
    s_nop 0
    buffer_load_dwordx4 v38, s[12:15], s32 offen sc1 lds
    s_add_u32 s32, s31, 4608
    s_mov_b32 m0, 75776
    s_nop 0
    buffer_load_dwordx4 v38, s[12:15], s32 offen sc1 lds
    s_add_u32 s32, s31, 8704
    s_mov_b32 m0, 76800
    s_nop 0
    buffer_load_dwordx4 v38, s[12:15], s32 offen sc1 lds
    s_add_u32 s32, s31, 12800
    s_mov_b32 m0, 77824
    s_mov_b32 exec_hi, 0
    buffer_load_dwordx4 v38, s[12:15], s32 offen sc1 lds
    s_mov_b64 exec, -1
    s_add_u32 s32, s31, 768
    s_mov_b32 m0, 78336
    s_nop 0
    buffer_load_dwordx4 v38, s[12:15], s32 offen sc1 lds
    s_add_u32 s32, s31, 4864
    s_mov_b32 m0, 79360
    s_nop 0
    buffer_load_dwordx4 v38, s[12:15], s32 offen sc1 lds
    s_add_u32 s32, s31, 8960
    s_mov_b32 m0, 80384
    s_nop 0
    buffer_load_dwordx4 v38, s[12:15], s32 offen sc1 lds
    s_add_u32 s32, s31, 13056
    s_mov_b32 m0, 81408
    s_mov_b32 exec_hi, 0
    buffer_load_dwordx4 v38, s[12:15], s32 offen sc1 lds
    s_mov_b64 exec, -1
    s_branch L_A_hend
L_A_h6:
    s_mov_b32 s87, 1
    s_branch L_A_n
L_A_h3:
    s_cmp_eq_u32 s24, 0
    s_cbranch_scc0 L_A_hend
    v_lshlrev_b32 v38, 7, v8
    s_mov_b32 s31, 0
    buffer_load_dwordx4 v[34:37], v38, s[12:15], s31 offen sc1
    s_branch L_A_hend
L_A_h4:
    s_cmp_eq_u32 s26, 1
    s_cbranch_scc0 L_A_hend
    s_cmp_lt_u32 s28, 8
    s_cbranch_scc0 L_A_h4y
    v_lshlrev_b32 v38, 10, v8
    s_cmp_eq_u32 s25, 3
    s_cbranch_scc1 L_tcw_d
    s_cmp_eq_u32 s25, 2
    s_cbranch_scc1 L_tcw_o
    s_mov_b32 s16, s94
    s_and_b32 s17, s95, 0xffff
    s_mov_b32 s18, 917504
    s_mov_b32 s19, 0x20000
    s_and_b32 s31, s78, 7
    s_mul_i32 s31, s31, 114688
    s_lshl_b32 s32, s25, 1
    s_add_u32 s32, s79, s32
    s_lshl_b32 s32, s32, 7
    s_add_u32 s31, s31, s32
    buffer_load_dword v36, v38, s[16:19], s31 offen
    s_add_u32 s31, s31, 57344
    buffer_load_dword v37, v38, s[16:19], s31 offen
    s_branch L_tcw_d
L_tcw_o:
    s_mov_b32 s16, s92
    s_and_b32 s17, s93, 0xffff
    s_mov_b32 s18, 524288
    s_mov_b32 s19, 0x20000
    s_and_b32 s31, s78, 7
    s_lshl_b32 s31, s31, 16
    s_lshl_b32 s32, s79, 7
    s_add_u32 s31, s31, s32
    buffer_load_dword v36, v38, s[16:19], s31 offen
    s_add_u32 s31, s31, 256
    buffer_load_dword v37, v38, s[16:19], s31 offen
L_tcw_d:
    s_branch L_A_hend
L_A_h4y:
    s_cmp_eq_u32 s47, 0
    s_cselect_b32 s8, s20, s22
    s_cselect_b32 s9, s21, s23
    s_cselect_b32 s10, s62, s63
    s_mov_b32 s11, 0x20000
    s_cselect_b64 vcc, -1, 0
    v_cndmask_b32 v7, v6, v5, vcc
    s_lshl_b32 s59, s47, 9
    s_add_u32 s59, s59, 3072
    s_lshl_b32 s72, s59, 6
    s_mul_i32 s73, s59, s24
    s_lshl_b32 s73, s73, 3
    s_add_u32 s73, s73, s43
    s_lshl_b32 s31, s25, 4
    s_mul_i32 s73, s59, s31
    s_add_u32 s73, s73, s43
    s_lshl_b32 s98, s59, 3
    s_lshl_b32 s99, s25, 11
    s_mov_b32 s101, 1
L_A_hend:
    s_cmp_eq_u32 s76, 1
    s_cbranch_scc1 L_A_M
    s_cmp_eq_u32 s76, 2
    s_cbranch_scc1 L_A_idle
    s_cmp_eq_u32 s82, 4
    s_cbranch_scc1 L_e_v
    s_cmp_ge_u32 s82, 2
    s_cbranch_scc1 L_e_q
    s_cmp_eq_u32 s82, 1
    s_cbranch_scc1 L_e_g2
    s_mul_i32 s31, s38, 56
    s_lshl_b32 s32, s83, 2
    s_add_u32 s31, s31, s32
    s_lshl_b32 s32, s39, 1
    s_add_u32 s31, s31, s32
    s_lshl_b32 s31, s31, 10
    s_add_u32 s31, s31, 6291456
    v_mul_f32 v96, v112, v112
    v_mul_f32 v97, v113, v113
    v_mul_f32 v98, v114, v114
    v_mul_f32 v99, v115, v115
    v_fma_f32 v96, v96, v10, v11
    v_fma_f32 v97, v97, v10, v11
    v_fma_f32 v98, v98, v10, v11
    v_fma_f32 v99, v99, v10, v11
    v_mul_f32 v96, v112, v96
    v_mul_f32 v97, v113, v97
    v_mul_f32 v98, v114, v98
    v_mul_f32 v99, v115, v99
    v_exp_f32 v104, v96
    v_exp_f32 v105, v97
    v_exp_f32 v106, v98
    v_exp_f32 v107, v99
    v_fma_f32 v104, v104, v12, v12
    v_fma_f32 v105, v105, v12, v12
    v_fma_f32 v106, v106, v12, v12
    v_fma_f32 v107, v107, v12, v12
    v_rcp_f32 v104, v104
    v_rcp_f32 v105, v105
    v_rcp_f32 v106, v106
    v_rcp_f32 v107, v107
    v_mul_f32 v112, v112, v104
    v_mul_f32 v113, v113, v105
    v_mul_f32 v114, v114, v106
    v_mul_f32 v115, v115, v107
    v_mul_f32 v100, v116, v116
    v_mul_f32 v101, v117, v117
    v_mul_f32 v102, v118, v118
    v_mul_f32 v103, v119, v119
    v_fma_f32 v100, v100, v10, v11
    v_fma_f32 v101, v101, v10, v11
    v_fma_f32 v102, v102, v10, v11
    v_fma_f32 v103, v103, v10, v11
    v_mul_f32 v100, v116, v100
    v_mul_f32 v101, v117, v101
    v_mul_f32 v102, v118, v102
    v_mul_f32 v103, v119, v103
    v_exp_f32 v108, v100
    v_exp_f32 v109, v101
    v_exp_f32 v110, v102
    v_exp_f32 v111, v103
    v_fma_f32 v108, v108, v12, v12
    v_fma_f32 v109, v109, v12, v12
    v_fma_f32 v110, v110, v12, v12
    v_fma_f32 v111, v111, v12, v12
    v_rcp_f32 v108, v108
    v_rcp_f32 v109, v109
    v_rcp_f32 v110, v110
    v_rcp_f32 v111, v111
    v_mul_f32 v116, v116, v108
    v_mul_f32 v117, v117, v109
    v_mul_f32 v118, v118, v110
    v_mul_f32 v119, v119, v111
    v_mul_f32 v96, v120, v120
    v_mul_f32 v97, v121, v121
    v_mul_f32 v98, v122, v122
    v_mul_f32 v99, v123, v123
    v_fma_f32 v96, v96, v10, v11
    v_fma_f32 v97, v97, v10, v11
    v_fma_f32 v98, v98, v10, v11
    v_fma_f32 v99, v99, v10, v11
    v_mul_f32 v96, v120, v96
    v_mul_f32 v97, v121, v97
    v_mul_f32 v98, v122, v98
    v_mul_f32 v99, v123, v99
    v_exp_f32 v104, v96
    v_exp_f32 v105, v97
    v_exp_f32 v106, v98
    v_exp_f32 v107, v99
    v_fma_f32 v104, v104, v12, v12
    v_fma_f32 v105, v105, v12, v12
    v_fma_f32 v106, v106, v12, v12
    v_fma_f32 v107, v107, v12, v12
    v_rcp_f32 v104, v104
    v_rcp_f32 v105, v105
    v_rcp_f32 v106, v106
    v_rcp_f32 v107, v107
    v_mul_f32 v120, v120, v104
    v_mul_f32 v121, v121, v105
    v_mul_f32 v122, v122, v106
    v_mul_f32 v123, v123, v107
    v_mul_f32 v100, v124, v124
    v_mul_f32 v101, v125, v125
    v_mul_f32 v102, v126, v126
    v_mul_f32 v103, v127, v127
    v_fma_f32 v100, v100, v10, v11
    v_fma_f32 v101, v101, v10, v11
    v_fma_f32 v102, v102, v10, v11
    v_fma_f32 v103, v103, v10, v11
    v_mul_f32 v100, v124, v100
    v_mul_f32 v101, v125, v101
    v_mul_f32 v102, v126, v102
    v_mul_f32 v103, v127, v103
    v_exp_f32 v108, v100
    v_exp_f32 v109, v101
    v_exp_f32 v110, v102
    v_exp_f32 v111, v103
    v_fma_f32 v108, v108, v12, v12
    v_fma_f32 v109, v109, v12, v12
    v_fma_f32 v110, v110, v12, v12
    v_fma_f32 v111, v111, v12, v12
    v_rcp_f32 v108, v108
    v_rcp_f32 v109, v109
    v_rcp_f32 v110, v110
    v_rcp_f32 v111, v111
    v_mul_f32 v124, v124, v108
    v_mul_f32 v125, v125, v109
    v_mul_f32 v126, v126, v110
    v_mul_f32 v127, v127, v111
    v_cvt_pk_bf16_f32 v72, v112, v113
    v_cvt_pk_bf16_f32 v73, v114, v115
    v_cvt_pk_bf16_f32 v74, v116, v117
    v_cvt_pk_bf16_f32 v75, v118, v119
    v_cvt_pk_bf16_f32 v76, v120, v121
    v_cvt_pk_bf16_f32 v77, v122, v123
    v_cvt_pk_bf16_f32 v78, v124, v125
    v_cvt_pk_bf16_f32 v79, v126, v127
    v_permlane16_swap_b32 v72, v74
    v_permlane16_swap_b32 v73, v75
    v_permlane16_swap_b32 v76, v78
    v_permlane16_swap_b32 v77, v79
    buffer_store_dwordx4 v[72:75], v2, s[12:15], s31 offen sc1
    buffer_store_dwordx4 v[76:79], v2, s[12:15], s31 offen offset:1024 sc1
    s_branch L_e_done
L_e_g2:
    v_mul_f32 v96, v112, v112
    v_mul_f32 v97, v113, v113
    v_mul_f32 v98, v114, v114
    v_mul_f32 v99, v115, v115
    v_fma_f32 v96, v96, v10, v11
    v_fma_f32 v97, v97, v10, v11
    v_fma_f32 v98, v98, v10, v11
    v_fma_f32 v99, v99, v10, v11
    v_mul_f32 v96, v112, v96
    v_mul_f32 v97, v113, v97
    v_mul_f32 v98, v114, v98
    v_mul_f32 v99, v115, v99
    v_exp_f32 v104, v96
    v_exp_f32 v105, v97
    v_exp_f32 v106, v98
    v_exp_f32 v107, v99
    v_fma_f32 v104, v104, v12, v12
    v_fma_f32 v105, v105, v12, v12
    v_fma_f32 v106, v106, v12, v12
    v_fma_f32 v107, v107, v12, v12
    v_rcp_f32 v104, v104
    v_rcp_f32 v105, v105
    v_rcp_f32 v106, v106
    v_rcp_f32 v107, v107
    v_mul_f32 v48, v112, v104
    v_mul_f32 v49, v113, v105
    v_mul_f32 v50, v114, v106
    v_mul_f32 v51, v115, v107
    v_mul_f32 v100, v116, v116
    v_mul_f32 v101, v117, v117
    v_mul_f32 v102, v118, v118
    v_mul_f32 v103, v119, v119
    v_fma_f32 v100, v100, v10, v11
    v_fma_f32 v101, v101, v10, v11
    v_fma_f32 v102, v102, v10, v11
    v_fma_f32 v103, v103, v10, v11
    v_mul_f32 v100, v116, v100
    v_mul_f32 v101, v117, v101
    v_mul_f32 v102, v118, v102
    v_mul_f32 v103, v119, v103
    v_exp_f32 v108, v100
    v_exp_f32 v109, v101
    v_exp_f32 v110, v102
    v_exp_f32 v111, v103
    v_fma_f32 v108, v108, v12, v12
    v_fma_f32 v109, v109, v12, v12
    v_fma_f32 v110, v110, v12, v12
    v_fma_f32 v111, v111, v12, v12
    v_rcp_f32 v108, v108
    v_rcp_f32 v109, v109
    v_rcp_f32 v110, v110
    v_rcp_f32 v111, v111
    v_mul_f32 v52, v116, v108
    v_mul_f32 v53, v117, v109
    v_mul_f32 v54, v118, v110
    v_mul_f32 v55, v119, v111
    v_mul_f32 v96, v120, v120
    v_mul_f32 v97, v121, v121
    v_mul_f32 v98, v122, v122
    v_mul_f32 v99, v123, v123
    v_fma_f32 v96, v96, v10, v11
    v_fma_f32 v97, v97, v10, v11
    v_fma_f32 v98, v98, v10, v11
    v_fma_f32 v99, v99, v10, v11
    v_mul_f32 v96, v120, v96
    v_mul_f32 v97, v121, v97
    v_mul_f32 v98, v122, v98
    v_mul_f32 v99, v123, v99
    v_exp_f32 v104, v96
    v_exp_f32 v105, v97
    v_exp_f32 v106, v98
    v_exp_f32 v107, v99
    v_fma_f32 v104, v104, v12, v12
    v_fma_f32 v105, v105, v12, v12
    v_fma_f32 v106, v106, v12, v12
    v_fma_f32 v107, v107, v12, v12
    v_rcp_f32 v104, v104
    v_rcp_f32 v105, v105
    v_rcp_f32 v106, v106
    v_rcp_f32 v107, v107
    v_mul_f32 v56, v120, v104
    v_mul_f32 v57, v121, v105
    v_mul_f32 v58, v122, v106
    v_mul_f32 v59, v123, v107
    v_mul_f32 v100, v124, v124
    v_mul_f32 v101, v125, v125
    v_mul_f32 v102, v126, v126
    v_mul_f32 v103, v127, v127
    v_fma_f32 v100, v100, v10, v11
    v_fma_f32 v101, v101, v10, v11
    v_fma_f32 v102, v102, v10, v11
    v_fma_f32 v103, v103, v10, v11
    v_mul_f32 v100, v124, v100
    v_mul_f32 v101, v125, v101
    v_mul_f32 v102, v126, v102
    v_mul_f32 v103, v127, v103
    v_exp_f32 v108, v100
    v_exp_f32 v109, v101
    v_exp_f32 v110, v102
    v_exp_f32 v111, v103
    v_fma_f32 v108, v108, v12, v12
    v_fma_f32 v109, v109, v12, v12
    v_fma_f32 v110, v110, v12, v12
    v_fma_f32 v111, v111, v12, v12
    v_rcp_f32 v108, v108
    v_rcp_f32 v109, v109
    v_rcp_f32 v110, v110
    v_rcp_f32 v111, v111
    v_mul_f32 v60, v124, v108
    v_mul_f32 v61, v125, v109
    v_mul_f32 v62, v126, v110
    v_mul_f32 v63, v127, v111
    v_add_f32 v96, v48, v49
    v_mul_f32 v97, v48, v48
    v_add_f32 v98, v50, v51
    v_mul_f32 v99, v49, v49
    v_fmac_f32 v97, v50, v50
    v_fmac_f32 v99, v51, v51
    v_fmac_f32 v97, v52, v52
    v_fmac_f32 v99, v53, v53
    v_add_f32 v100, v52, v53
    v_add_f32 v96, v96, v100
    v_fmac_f32 v97, v54, v54
    v_fmac_f32 v99, v55, v55
    v_add_f32 v100, v54, v55
    v_add_f32 v98, v98, v100
    v_fmac_f32 v97, v56, v56
    v_fmac_f32 v99, v57, v57
    v_add_f32 v100, v56, v57
    v_add_f32 v96, v96, v100
    v_fmac_f32 v97, v58, v58
    v_fmac_f32 v99, v59, v59
    v_add_f32 v100, v58, v59
    v_add_f32 v98, v98, v100
    v_fmac_f32 v97, v60, v60
    v_fmac_f32 v99, v61, v61
    v_add_f32 v100, v60, v61
    v_add_f32 v96, v96, v100
    v_fmac_f32 v97, v62, v62
    v_fmac_f32 v99, v63, v63
    v_add_f32 v100, v62, v63
    v_add_f32 v98, v98, v100
    v_add_f32 v96, v96, v98
    v_add_f32 v97, v97, v99
    v_mov_b32 v98, v96
    v_mov_b32 v99, v97
    s_nop 0
    v_permlane32_swap_b32 v96, v98
    v_permlane32_swap_b32 v97, v99
    v_add_f32 v96, v96, v98
    v_add_f32 v97, v97, v99
    v_and_b32 v100, 31, v8
    v_lshlrev_b32 v100, 3, v100
    s_lshl_b32 s31, s25, 8
    s_add_u32 s31, s31, 67584
    v_add_u32 v101, s31, v100
    s_cmp_eq_u32 s26, 1
    s_cbranch_scc1 L_e_g2p1
    ds_write_b64 v101, v[96:97]
    s_branch L_e_done
L_e_g2p1:
    ds_read_b64 v[102:103], v101
    s_lshl_b32 s31, s27, 4
    s_add_u32 s31, s31, s28
    s_lshl_b32 s31, s31, 10
    s_lshl_b32 s32, s25, 8
    s_add_u32 s31, s31, s32
    s_add_u32 s31, s31, 196608
    s_waitcnt lgkmcnt(0)
    v_add_f32 v96, v96, v102
    v_add_f32 v97, v97, v103
    v_cmp_gt_u32 vcc, 32, v8
    s_nop 3
    s_and_saveexec_b64 s[60:61], vcc
    buffer_store_dwordx2 v[96:97], v100, s[12:15], s31 offen sc1
    s_mov_b64 exec, s[60:61]
    s_branch L_e_done
L_e_q:
    s_cmp_eq_u32 s101, 1
    s_cbranch_scc0 L_b3_1
    s_mul_i32 s31, s64, s72
    s_add_u32 m0, s99, 98304
    s_add_u32 s31, s31, s73
    buffer_load_dwordx4 v7, s[8:11], s31 offen lds
    s_add_u32 m0, s99, 99328
    s_add_u32 s31, s31, s98
    buffer_load_dwordx4 v7, s[8:11], s31 offen lds
    s_mul_i32 s31, s65, s72
    s_add_u32 m0, s99, 106496
    s_add_u32 s31, s31, s73
    buffer_load_dwordx4 v7, s[8:11], s31 offen lds
    s_add_u32 m0, s99, 107520
    s_add_u32 s31, s31, s98
    buffer_load_dwordx4 v7, s[8:11], s31 offen lds
L_b3_1:
    v_min_f32 v96, 0, v112
    v_min_f32 v97, 0, v113
    v_min_f32 v98, 0, v114
    v_min_f32 v99, 0, v115
    v_mul_f32 v96, v96, v14
    v_mul_f32 v97, v97, v14
    v_mul_f32 v98, v98, v14
    v_mul_f32 v99, v99, v14
    v_exp_f32 v96, v96
    v_exp_f32 v97, v97
    v_exp_f32 v98, v98
    v_exp_f32 v99, v99
    v_max_f32 v112, 0, v112
    v_max_f32 v113, 0, v113
    v_max_f32 v114, 0, v114
    v_max_f32 v115, 0, v115
    v_add_f32 v96, s81, v96
    v_add_f32 v97, s81, v97
    v_add_f32 v98, s81, v98
    v_add_f32 v99, s81, v99
    v_fma_f32 v112, v112, v13, v96
    v_fma_f32 v113, v113, v13, v97
    v_fma_f32 v114, v114, v13, v98
    v_fma_f32 v115, v115, v13, v99
    s_cmp_eq_u32 s101, 1
    s_cbranch_scc0 L_b3_2
    s_mul_i32 s31, s66, s72
    s_add_u32 m0, s99, 114688
    s_add_u32 s31, s31, s73
    buffer_load_dwordx4 v7, s[8:11], s31 offen lds
    s_add_u32 m0, s99, 115712
    s_add_u32 s31, s31, s98
    buffer_load_dwordx4 v7, s[8:11], s31 offen lds
    s_mul_i32 s31, s67, s72
    s_add_u32 m0, s99, 122880
    s_add_u32 s31, s31, s73
    buffer_load_dwordx4 v7, s[8:11], s31 offen lds
    s_add_u32 m0, s99, 123904
    s_add_u32 s31, s31, s98
    buffer_load_dwordx4 v7, s[8:11], s31 offen lds
L_b3_2:
    v_min_f32 v100, 0, v116
    v_min_f32 v101, 0, v117
    v_min_f32 v102, 0, v118
    v_min_f32 v103, 0, v119
    v_mul_f32 v100, v100, v14
    v_mul_f32 v101, v101, v14
    v_mul_f32 v102, v102, v14
    v_mul_f32 v103, v103, v14
    v_exp_f32 v100, v100
    v_exp_f32 v101, v101
    v_exp_f32 v102, v102
    v_exp_f32 v103, v103
    v_max_f32 v116, 0, v116
    v_max_f32 v117, 0, v117
    v_max_f32 v118, 0, v118
    v_max_f32 v119, 0, v119
    v_add_f32 v100, s81, v100
    v_add_f32 v101, s81, v101
    v_add_f32 v102, s81, v102
    v_add_f32 v103, s81, v103
    v_fma_f32 v116, v116, v13, v100
    v_fma_f32 v117, v117, v13, v101
    v_fma_f32 v118, v118, v13, v102
    v_fma_f32 v119, v119, v13, v103
    s_cmp_eq_u32 s101, 1
    s_cbranch_scc0 L_b3_3
    s_mul_i32 s31, s68, s72
    s_add_u32 m0, s99, 131072
    s_add_u32 s31, s31, s73
    buffer_load_dwordx4 v7, s[8:11], s31 offen lds
    s_add_u32 m0, s99, 132096
    s_add_u32 s31, s31, s98
    buffer_load_dwordx4 v7, s[8:11], s31 offen lds
    s_mul_i32 s31, s69, s72
    s_add_u32 m0, s99, 139264
    s_add_u32 s31, s31, s73
    buffer_load_dwordx4 v7, s[8:11], s31 offen lds
    s_add_u32 m0, s99, 140288
    s_add_u32 s31, s31, s98
    buffer_load_dwordx4 v7, s[8:11], s31 offen lds
L_b3_3:
    v_min_f32 v96, 0, v120
    v_min_f32 v97, 0, v121
    v_min_f32 v98, 0, v122
    v_min_f32 v99, 0, v123
    v_mul_f32 v96, v96, v14
    v_mul_f32 v97, v97, v14
    v_mul_f32 v98, v98, v14
    v_mul_f32 v99, v99, v14
    v_exp_f32 v96, v96
    v_exp_f32 v97, v97
    v_exp_f32 v98, v98
    v_exp_f32 v99, v99
    v_max_f32 v120, 0, v120
    v_max_f32 v121, 0, v121
    v_max_f32 v122, 0, v122
    v_max_f32 v123, 0, v123
    v_add_f32 v96, s81, v96
    v_add_f32 v97, s81, v97
    v_add_f32 v98, s81, v98
    v_add_f32 v99, s81, v99
    v_fma_f32 v120, v120, v13, v96
    v_fma_f32 v121, v121, v13, v97
    v_fma_f32 v122, v122, v13, v98
    v_fma_f32 v123, v123, v13, v99
    s_cmp_eq_u32 s101, 1
    s_cbranch_scc0 L_b3_4
    s_mul_i32 s31, s70, s72
    s_add_u32 m0, s99, 147456
    s_add_u32 s31, s31, s73
    buffer_load_dwordx4 v7, s[8:11], s31 offen lds
    s_add_u32 m0, s99, 148480
    s_add_u32 s31, s31, s98
    buffer_load_dwordx4 v7, s[8:11], s31 offen lds
    s_mul_i32 s31, s71, s72
    s_add_u32 m0, s99, 155648
    s_add_u32 s31, s31, s73
    buffer_load_dwordx4 v7, s[8:11], s31 offen lds
    s_add_u32 m0, s99, 156672
    s_add_u32 s31, s31, s98
    buffer_load_dwordx4 v7, s[8:11], s31 offen lds
L_b3_4:
    v_min_f32 v100, 0, v124
    v_min_f32 v101, 0, v125
    v_min_f32 v102, 0, v126
    v_min_f32 v103, 0, v127
    v_mul_f32 v100, v100, v14
    v_mul_f32 v101, v101, v14
    v_mul_f32 v102, v102, v14
    v_mul_f32 v103, v103, v14
    v_exp_f32 v100, v100
    v_exp_f32 v101, v101
    v_exp_f32 v102, v102
    v_exp_f32 v103, v103
    v_max_f32 v124, 0, v124
    v_max_f32 v125, 0, v125
    v_max_f32 v126, 0, v126
    v_max_f32 v127, 0, v127
    v_add_f32 v100, s81, v100
    v_add_f32 v101, s81, v101
    v_add_f32 v102, s81, v102
    v_add_f32 v103, s81, v103
    v_fma_f32 v124, v124, v13, v100
    v_fma_f32 v125, v125, v13, v101
    v_fma_f32 v126, v126, v13, v102
    v_fma_f32 v127, v127, v13, v103
    v_cvt_pk_bf16_f32 v72, v112, v113
    v_cvt_pk_bf16_f32 v73, v114, v115
    v_cvt_pk_bf16_f32 v74, v116, v117
    v_cvt_pk_bf16_f32 v75, v118, v119
    v_cvt_pk_bf16_f32 v76, v120, v121
    v_cvt_pk_bf16_f32 v77, v122, v123
    v_cvt_pk_bf16_f32 v78, v124, v125
    v_cvt_pk_bf16_f32 v79, v126, v127
    s_cmp_eq_u32 s82, 3
    s_cbranch_scc1 L_e_k
    s_lshl_b32 s31, s38, 5
    s_lshl_b32 s32, s83, 2
    s_add_u32 s31, s31, s32
    s_lshl_b32 s32, s39, 1
    s_add_u32 s31, s31, s32
    s_lshl_b32 s31, s31, 10
    s_add_u32 s31, s31, 10485760
    buffer_store_dwordx4 v[72:75], v1, s[12:15], s31 offen sc1
    buffer_store_dwordx4 v[76:79], v1, s[12:15], s31 offen offset:1024 sc1
    s_branch L_e_done
L_e_k:
    s_lshl_b32 s31, s24, 8
    s_add_u32 s31, s31, 65536
    v_lshlrev_b32 v98, 2, v8
    v_add_u32 v98, s31, v98
    v_mfma_f32_32x32x16_bf16 v[80:95], v[72:75], v[24:27], 0
    v_mfma_f32_32x32x16_bf16 v[80:95], v[76:79], v[28:31], v[80:95]
    s_nop 11
    v_cvt_pk_bf16_f32 v64, v80, v81
    v_cvt_pk_bf16_f32 v65, v82, v83
    v_cvt_pk_bf16_f32 v66, v84, v85
    v_cvt_pk_bf16_f32 v67, v86, v87
    v_cvt_pk_bf16_f32 v68, v88, v89
    v_cvt_pk_bf16_f32 v69, v90, v91
    v_cvt_pk_bf16_f32 v70, v92, v93
    v_cvt_pk_bf16_f32 v71, v94, v95
    v_add_f32 v80, v80, v88
    v_add_f32 v81, v81, v89
    v_add_f32 v82, v82, v90
    v_add_f32 v83, v83, v91
    v_add_f32 v84, v84, v92
    v_add_f32 v85, v85, v93
    v_add_f32 v86, v86, v94
    v_add_f32 v87, v87, v95
    v_add_f32 v80, v80, v84
    v_add_f32 v81, v81, v85
    v_add_f32 v82, v82, v86
    v_add_f32 v83, v83, v87
    v_add_f32 v80, v80, v82
    v_add_f32 v81, v81, v83
    v_add_f32 v96, v80, v81
    ds_write_b32 v98, v96
    s_branch L_e_done
L_e_v:
    v_mul_f32 v112, v112, v13
    v_mul_f32 v113, v113, v13
    v_mul_f32 v114, v114, v13
    v_mul_f32 v115, v115, v13
    v_mul_f32 v116, v116, v13
    v_mul_f32 v117, v117, v13
    v_mul_f32 v118, v118, v13
    v_mul_f32 v119, v119, v13
    v_mul_f32 v120, v120, v13
    v_mul_f32 v121, v121, v13
    v_mul_f32 v122, v122, v13
    v_mul_f32 v123, v123, v13
    v_mul_f32 v124, v124, v13
    v_mul_f32 v125, v125, v13
    v_mul_f32 v126, v126, v13
    v_mul_f32 v127, v127, v13
    v_cvt_pk_bf16_f32 v72, v112, v113
    v_cvt_pk_bf16_f32 v73, v114, v115
    v_cvt_pk_bf16_f32 v74, v116, v117
    v_cvt_pk_bf16_f32 v75, v118, v119
    v_cvt_pk_bf16_f32 v76, v120, v121
    v_cvt_pk_bf16_f32 v77, v122, v123
    v_cvt_pk_bf16_f32 v78, v124, v125
    v_cvt_pk_bf16_f32 v79, v126, v127
    v_mfma_f32_32x32x16_bf16 v[80:95], v[72:75], v[24:27], 0
    s_nop 0
    v_mfma_f32_32x32x16_bf16 v[80:95], v[76:79], v[28:31], v[80:95]
    s_nop 11
    v_cvt_pk_bf16_f32 v72, v80, v81
    v_cvt_pk_bf16_f32 v73, v82, v83
    v_cvt_pk_bf16_f32 v74, v84, v85
    v_cvt_pk_bf16_f32 v75, v86, v87
    v_cvt_pk_bf16_f32 v76, v88, v89
    v_cvt_pk_bf16_f32 v77, v90, v91
    v_cvt_pk_bf16_f32 v78, v92, v93
    v_cvt_pk_bf16_f32 v79, v94, v95
    v_mfma_f32_32x32x16_bf16 v[80:95], v[64:67], v[72:75], 0
    s_nop 0
    v_mfma_f32_32x32x16_bf16 v[80:95], v[68:71], v[76:79], v[80:95]
    v_and_b32 v96, 16, v8
    v_cmp_eq_u32 vcc, 0, v96
    s_lshl_b32 s31, s24, 11
    s_add_u32 s31, s31, 81920
    v_lshlrev_b32 v105, 2, v8
    v_add_u32 v105, s31, v105
    s_nop 5
    v_cndmask_b32 v97, v88, v80, vcc
    v_cndmask_b32 v98, v89, v81, vcc
    v_cndmask_b32 v99, v90, v82, vcc
    v_cndmask_b32 v100, v91, v83, vcc
    v_cndmask_b32 v101, v92, v84, vcc
    v_cndmask_b32 v102, v93, v85, vcc
    v_cndmask_b32 v103, v94, v86, vcc
    v_cndmask_b32 v104, v95, v87, vcc
    ds_write_b32 v105, v97 offset:0
    ds_write_b32 v105, v98 offset:256
    ds_write_b32 v105, v99 offset:512
    ds_write_b32 v105, v100 offset:768
    ds_write_b32 v105, v101 offset:1024
    ds_write_b32 v105, v102 offset:1280
    ds_write_b32 v105, v103 offset:1536
    ds_write_b32 v105, v104 offset:1792
L_e_done:
    s_mov_b32 s101, 0
    s_add_u32 s58, s58, 1
    s_cmp_lt_u32 s58, s37
    s_cselect_b32 s76, 1, 3
    s_branch L_A_w
L_A_M:
    s_mov_b32 s56, 98304
    s_mov_b32 s57, 131072
    s_and_b32 s31, s28, 1
    s_cmp_eq_u32 s58, 2
    s_cselect_b32 s56, 0, s56
    s_cselect_b32 s57, 32768, s57
    s_cselect_b32 s82, s50, s49
    s_cselect_b32 s83, s54, s53
    s_cmp_eq_u32 s58, 3
    s_cselect_b32 s82, s51, s82
    s_cselect_b32 s83, s55, s83
    s_cselect_b32 s39, s31, s26
    s_lshl_b32 s31, s39, 6
    v_xor_b32 v32, s31, v4
    v_add_u32 v33, s57, v32
    v_add_u32 v32, s56, v32
    ds_read_b64_tr_b16 v[80:81], v32 offset:0
    ds_read_b64_tr_b16 v[82:83], v32 offset:512
    ds_read_b64_tr_b16 v[84:85], v32 offset:2048
    ds_read_b64_tr_b16 v[86:87], v32 offset:2560
    ds_read_b64_tr_b16 v[88:89], v32 offset:4096
    ds_read_b64_tr_b16 v[90:91], v32 offset:4608
    ds_read_b64_tr_b16 v[92:93], v32 offset:6144
    ds_read_b64_tr_b16 v[94:95], v32 offset:6656
    ds_read_b64_tr_b16 v[96:97], v32 offset:8192
    ds_read_b64_tr_b16 v[98:99], v32 offset:8704
    ds_read_b64_tr_b16 v[100:101], v32 offset:10240
    ds_read_b64_tr_b16 v[102:103], v32 offset:10752
    s_cmp_eq_u32 s58, 2
    s_cselect_b64 vcc, -1, 0
    v_cndmask_b32 v20, v42, v44, vcc
    v_cndmask_b32 v21, v43, v45, vcc
    s_cmp_eq_u32 s58, 3
    s_cselect_b64 vcc, -1, 0
    v_cndmask_b32 v20, v20, v46, vcc
    v_cndmask_b32 v21, v21, v47, vcc
    ds_read_b64_tr_b16 v[104:105], v32 offset:12288
    ds_read_b64_tr_b16 v[106:107], v32 offset:12800
    s_waitcnt lgkmcnt(12)
    v_mfma_f32_32x32x16_bf16 v[112:127], v[80:83], v[128:131], 0
    ds_read_b64_tr_b16 v[108:109], v32 offset:14336
    ds_read_b64_tr_b16 v[110:111], v32 offset:14848
    s_waitcnt lgkmcnt(12)
    v_mfma_f32_32x32x16_bf16 v[112:127], v[84:87], v[132:135], v[112:127]
    ds_read_b64_tr_b16 v[80:81], v32 offset:16384
    ds_read_b64_tr_b16 v[82:83], v32 offset:16896
    s_waitcnt lgkmcnt(12)
    v_mfma_f32_32x32x16_bf16 v[112:127], v[88:91], v[136:139], v[112:127]
    ds_read_b64_tr_b16 v[84:85], v32 offset:18432
    ds_read_b64_tr_b16 v[86:87], v32 offset:18944
    s_waitcnt lgkmcnt(12)
    v_mfma_f32_32x32x16_bf16 v[112:127], v[92:95], v[140:143], v[112:127]
    ds_read_b64_tr_b16 v[88:89], v32 offset:20480
    ds_read_b64_tr_b16 v[90:91], v32 offset:20992
    s_waitcnt lgkmcnt(12)
    v_mfma_f32_32x32x16_bf16 v[112:127], v[96:99], v[144:147], v[112:127]
    ds_read_b64_tr_b16 v[92:93], v32 offset:22528
    ds_read_b64_tr_b16 v[94:95], v32 offset:23040
    s_waitcnt lgkmcnt(12)
    v_mfma_f32_32x32x16_bf16 v[112:127], v[100:103], v[148:151], v[112:127]
    ds_read_b64_tr_b16 v[96:97], v32 offset:24576
    ds_read_b64_tr_b16 v[98:99], v32 offset:25088
    s_waitcnt lgkmcnt(12)
    v_mfma_f32_32x32x16_bf16 v[112:127], v[104:107], v[152:155], v[112:127]
    ds_read_b64_tr_b16 v[100:101], v32 offset:26624
    ds_read_b64_tr_b16 v[102:103], v32 offset:27136
    s_waitcnt lgkmcnt(12)
    v_mfma_f32_32x32x16_bf16 v[112:127], v[108:111], v[156:159], v[112:127]
    ds_read_b64_tr_b16 v[104:105], v32 offset:28672
    ds_read_b64_tr_b16 v[106:107], v32 offset:29184
    s_waitcnt lgkmcnt(12)
    v_mfma_f32_32x32x16_bf16 v[112:127], v[80:83], v[160:163], v[112:127]
    ds_read_b64_tr_b16 v[108:109], v32 offset:30720
    ds_read_b64_tr_b16 v[110:111], v32 offset:31232
    s_waitcnt lgkmcnt(12)
    v_mfma_f32_32x32x16_bf16 v[112:127], v[84:87], v[164:167], v[112:127]
    ds_read_b64_tr_b16 v[80:81], v33 offset:0
    ds_read_b64_tr_b16 v[82:83], v33 offset:512
    s_waitcnt lgkmcnt(12)
    v_mfma_f32_32x32x16_bf16 v[112:127], v[88:91], v[168:171], v[112:127]
    ds_read_b64_tr_b16 v[84:85], v33 offset:2048
    ds_read_b64_tr_b16 v[86:87], v33 offset:2560
    s_waitcnt lgkmcnt(12)
    v_mfma_f32_32x32x16_bf16 v[112:127], v[92:95], v[172:175], v[112:127]
    ds_read_b64_tr_b16 v[88:89], v33 offset:4096
    ds_read_b64_tr_b16 v[90:91], v33 offset:4608
    s_waitcnt lgkmcnt(12)
    v_mfma_f32_32x32x16_bf16 v[112:127], v[96:99], v[176:179], v[112:127]
    ds_read_b64_tr_b16 v[92:93], v33 offset:6144
    ds_read_b64_tr_b16 v[94:95], v33 offset:6656
    s_waitcnt lgkmcnt(12)
    v_mfma_f32_32x32x16_bf16 v[112:127], v[100:103], v[180:183], v[112:127]
    ds_read_b64_tr_b16 v[96:97], v33 offset:8192
    ds_read_b64_tr_b16 v[98:99], v33 offset:8704
    s_waitcnt lgkmcnt(12)
    v_mfma_f32_32x32x16_bf16 v[112:127], v[104:107], v[184:187], v[112:127]
    ds_read_b64_tr_b16 v[100:101], v33 offset:10240
    ds_read_b64_tr_b16 v[102:103], v33 offset:10752
    s_waitcnt lgkmcnt(12)
    v_mfma_f32_32x32x16_bf16 v[112:127], v[108:111], v[188:191], v[112:127]
    ds_read_b64_tr_b16 v[104:105], v33 offset:12288
    ds_read_b64_tr_b16 v[106:107], v33 offset:12800
    s_waitcnt lgkmcnt(12)
    v_mfma_f32_32x32x16_bf16 v[112:127], v[80:83], v[192:195], v[112:127]
    ds_read_b64_tr_b16 v[108:109], v33 offset:14336
    ds_read_b64_tr_b16 v[110:111], v33 offset:14848
    s_waitcnt lgkmcnt(12)
    v_mfma_f32_32x32x16_bf16 v[112:127], v[84:87], v[196:199], v[112:127]
    ds_read_b64_tr_b16 v[80:81], v33 offset:16384
    ds_read_b64_tr_b16 v[82:83], v33 offset:16896
    s_waitcnt lgkmcnt(12)
    v_mfma_f32_32x32x16_bf16 v[112:127], v[88:91], v[200:203], v[112:127]
    ds_read_b64_tr_b16 v[84:85], v33 offset:18432
    ds_read_b64_tr_b16 v[86:87], v33 offset:18944
    s_waitcnt lgkmcnt(12)
    v_mfma_f32_32x32x16_bf16 v[112:127], v[92:95], v[204:207], v[112:127]
    ds_read_b64_tr_b16 v[88:89], v33 offset:20480
    ds_read_b64_tr_b16 v[90:91], v33 offset:20992
    s_waitcnt lgkmcnt(12)
    v_mfma_f32_32x32x16_bf16 v[112:127], v[96:99], v[208:211], v[112:127]
    ds_read_b64_tr_b16 v[92:93], v33 offset:22528
    ds_read_b64_tr_b16 v[94:95], v33 offset:23040
    s_waitcnt lgkmcnt(12)
    v_mfma_f32_32x32x16_bf16 v[112:127], v[100:103], v[212:215], v[112:127]
    ds_read_b64_tr_b16 v[96:97], v33 offset:24576
    ds_read_b64_tr_b16 v[98:99], v33 offset:25088
    s_waitcnt lgkmcnt(12)
    v_mfma_f32_32x32x16_bf16 v[112:127], v[104:107], v[216:219], v[112:127]
    ds_read_b64_tr_b16 v[100:101], v33 offset:26624
    ds_read_b64_tr_b16 v[102:103], v33 offset:27136
    s_waitcnt lgkmcnt(12)
    v_mfma_f32_32x32x16_bf16 v[112:127], v[108:111], v[220:223], v[112:127]
    ds_read_b64_tr_b16 v[104:105], v33 offset:28672
    ds_read_b64_tr_b16 v[106:107], v33 offset:29184
    s_waitcnt lgkmcnt(12)
    v_mfma_f32_32x32x16_bf16 v[112:127], v[80:83], v[224:227], v[112:127]
    ds_read_b64_tr_b16 v[108:109], v33 offset:30720
    ds_read_b64_tr_b16 v[110:111], v33 offset:31232
    s_waitcnt lgkmcnt(12)
    v_mfma_f32_32x32x16_bf16 v[112:127], v[84:87], v[228:231], v[112:127]
    s_waitcnt lgkmcnt(10)
    v_mfma_f32_32x32x16_bf16 v[112:127], v[88:91], v[232:235], v[112:127]
    s_waitcnt lgkmcnt(8)
    v_mfma_f32_32x32x16_bf16 v[112:127], v[92:95], v[236:239], v[112:127]
    s_waitcnt lgkmcnt(6)
    v_mfma_f32_32x32x16_bf16 v[112:127], v[96:99], v[240:243], v[112:127]
    s_waitcnt lgkmcnt(4)
    v_mfma_f32_32x32x16_bf16 v[112:127], v[100:103], v[244:247], v[112:127]
    s_waitcnt lgkmcnt(2)
    v_mfma_f32_32x32x16_bf16 v[112:127], v[104:107], v[248:251], v[112:127]
    s_waitcnt lgkmcnt(0)
    v_mfma_f32_32x32x16_bf16 v[112:127], v[108:111], v[252:255], v[112:127]
    v_mfma_f32_32x32x16_bf16 v[112:127], v[20:23], v[16:19], v[112:127]
    s_mov_b32 s76, 0
    s_cmp_eq_u32 s36, 3
    s_cbranch_scc1 L_A_mw3
    s_cmp_eq_u32 s36, 5
    s_cbranch_scc0 L_A_bar
    s_cmp_lt_u32 s28, 8
    s_cbranch_scc1 L_A_bar
    s_waitcnt vmcnt(2)
    s_branch L_A_bar
L_A_mw3:
    s_waitcnt vmcnt(3)
    s_branch L_A_bar
L_A_idle:
    s_mov_b32 s76, 0
L_A_w:
    s_cmp_eq_u32 s36, 1
    s_cbranch_scc1 L_A_w1
    s_cmp_eq_u32 s36, 5
    s_cbranch_scc0 L_A_bar
    s_cmp_eq_u32 s24, 0
    s_cbranch_scc0 L_A_bar
    s_cmp_lt_u32 s28, 8
    s_cbranch_scc1 L_A_w50
    s_waitcnt vmcnt(2)
    s_branch L_A_bar
L_A_w50:
    s_waitcnt vmcnt(0)
    s_branch L_A_bar
L_A_w1:
    s_cmp_eq_u32 s26, 1
    s_cbranch_scc1 L_A_w1b
    s_waitcnt vmcnt(1)
    s_branch L_A_bar
L_A_w1b:
    s_waitcnt vmcnt(16)
    s_cmp_lt_u32 s28, 8
    s_cbranch_scc0 L_A_t2
    s_and_b32 s31, s78, 7
    s_lshl_b32 s31, s31, 0
    s_add_u32 s31, s31, 0
    v_and_b32 v38, 15, v8
    v_add_u32 v38, s31, v38
    v_and_b32 v38, 31, v38
    v_lshlrev_b32 v38, 7, v38
    v_lshrrev_b32 v39, 4, v8
    v_lshl_add_u32 v38, v39, 12, v38
    s_mov_b32 s16, s88
    s_and_b32 s17, s89, 0xffff
    s_mov_b32 s18, 8388608
    s_mov_b32 s19, 0x20000
    s_lshl_b32 s31, s78, 6
    s_and_b32 s32, s79, 1
    s_lshl_b32 s32, s32, 5
    s_add_u32 s31, s31, s32
    s_lshl_b32 s32, s25, 3
    s_add_u32 s31, s31, s32
    s_lshl_b32 s31, s31, 12
    buffer_load_dword v34, v38, s[16:19], s31 offen
    s_add_u32 s31, s31, 16384
    buffer_load_dword v35, v38, s[16:19], s31 offen
    s_branch L_A_bar
L_A_t2:
    s_and_b32 s31, s78, 7
    s_lshl_b32 s31, s31, 0
    s_add_u32 s31, s31, 16
    v_and_b32 v38, 15, v8
    v_add_u32 v38, s31, v38
    v_and_b32 v38, 31, v38
    v_lshlrev_b32 v38, 7, v38
    v_lshrrev_b32 v39, 4, v8
    v_lshl_add_u32 v38, v39, 12, v38
    s_mov_b32 s16, s88
    s_and_b32 s17, s89, 0xffff
    s_mov_b32 s18, 8388608
    s_mov_b32 s19, 0x20000
    s_lshl_b32 s31, s78, 6
    s_and_b32 s32, s79, 1
    s_lshl_b32 s32, s32, 5
    s_add_u32 s31, s31, s32
    s_lshl_b32 s32, s25, 3
    s_add_u32 s31, s31, s32
    s_lshl_b32 s31, s31, 12
    buffer_load_dword v34, v38, s[16:19], s31 offen
    s_add_u32 s31, s31, 16384
    buffer_load_dword v35, v38, s[16:19], s31 offen
L_A_bar:
    s_bitcmp1_b32 s36, 0
    s_cbranch_scc0 L_A_nobar
    s_cmp_eq_u32 s36, 7
    s_cbranch_scc1 L_A_nobar
    s_waitcnt lgkmcnt(0)
    s_barrier
L_A_nobar:
    s_add_u32 s36, s36, 1
    s_cmp_gt_u32 s36, s77
    s_cbranch_scc1 L_A_done
    s_cmp_eq_u32 s76, 3
    s_cbranch_scc0 L_A_loop
L_A_done:
    s_cmp_eq_u32 s87, 1
    s_cbranch_scc1 L_A_d1
    s_mov_b32 s87, 2
L_A_n:
    s_cmp_lg_u32 s48, 1
    s_cbranch_scc1 L_n_skip
    v_lshrrev_b32 v110, 5, v8
    v_mul_u32_u24 v110, 1792, v110
    v_and_b32 v111, 31, v8
    v_lshl_add_u32 v110, v111, 3, v110
    s_mul_i32 s31, s25, 3584
    s_add_u32 s31, s31, 67584
    v_add_u32 v110, s31, v110
    ds_read_b64 v[96:97], v110 offset:0
    ds_read_b64 v[98:99], v110 offset:256
    ds_read_b64 v[100:101], v110 offset:512
    ds_read_b64 v[102:103], v110 offset:768
    ds_read_b64 v[104:105], v110 offset:1024
    ds_read_b64 v[106:107], v110 offset:1280
    ds_read_b64 v[108:109], v110 offset:1536
    s_waitcnt lgkmcnt(0)
    v_max3_u32 v111, v96, v97, v98
    v_max3_u32 v111, v111, v99, v100
    v_max3_u32 v111, v111, v101, v102
    v_max3_u32 v111, v111, v103, v104
    v_max3_u32 v111, v111, v105, v106
    v_max3_u32 v111, v111, v107, v108
    v_max_u32 v111, v111, v109
    v_cmp_eq_u32 vcc, -1, v111
    s_nop 3
    s_cbranch_vccz L_n_ok
    v_lshrrev_b32 v110, 5, v8
    v_mul_u32_u24 v110, 7168, v110
    v_and_b32 v111, 31, v8
    v_lshl_add_u32 v110, v111, 3, v110
    s_lshl_b32 s31, s27, 14
    s_lshl_b32 s32, s25, 8
    s_add_u32 s31, s31, s32
    s_add_u32 s31, s31, 196608
    s_add_u32 s32, s31, 4096
    s_mov_b32 s80, 0
L_n_poll:
    buffer_load_dwordx2 v[96:97], v110, s[12:15], s31 offen offset:0 sc1
    buffer_load_dwordx2 v[98:99], v110, s[12:15], s31 offen offset:1024 sc1
    buffer_load_dwordx2 v[100:101], v110, s[12:15], s31 offen offset:2048 sc1
    buffer_load_dwordx2 v[102:103], v110, s[12:15], s31 offen offset:3072 sc1
    buffer_load_dwordx2 v[104:105], v110, s[12:15], s32 offen offset:0 sc1
    buffer_load_dwordx2 v[106:107], v110, s[12:15], s32 offen offset:1024 sc1
    buffer_load_dwordx2 v[108:109], v110, s[12:15], s32 offen offset:2048 sc1
    s_waitcnt vmcnt(0)
    v_max3_u32 v111, v96, v97, v98
    v_max3_u32 v111, v111, v99, v100
    v_max3_u32 v111, v111, v101, v102
    v_max3_u32 v111, v111, v103, v104
    v_max3_u32 v111, v111, v105, v106
    v_max3_u32 v111, v111, v107, v108
    v_max_u32 v111, v111, v109
    v_cmp_eq_u32 vcc, -1, v111
    s_add_u32 s80, s80, 1
    s_cmp_gt_u32 s80, 200000
    s_cbranch_scc1 L_n_ok
    s_nop 0
    s_cbranch_vccnz L_n_poll
L_n_ok:
    v_add_f32 v96, v96, v98
    v_add_f32 v97, v97, v99
    v_add_f32 v96, v96, v100
    v_add_f32 v97, v97, v101
    v_add_f32 v96, v96, v102
    v_add_f32 v97, v97, v103
    v_add_f32 v96, v96, v104
    v_add_f32 v97, v97, v105
    v_add_f32 v96, v96, v106
    v_add_f32 v97, v97, v107
    v_add_f32 v96, v96, v108
    v_add_f32 v97, v97, v109
    v_mov_b32 v98, v96
    v_mov_b32 v99, v97
    s_nop 0
    v_permlane32_swap_b32 v96, v98
    v_permlane32_swap_b32 v97, v99
    v_add_f32 v96, v96, v98
    v_add_f32 v97, v97, v99
    v_mul_f32 v96, 0x3a924925, v96
    v_mul_f32 v97, 0x3a924925, v97
    v_fma_f32 v97, -v96, v96, v97
    v_max_f32 v97, 0, v97
    v_add_f32 v97, 0x3727c5ac, v97
    v_rsq_f32 v97, v97
    s_lshl_b32 s31, s28, 2
    s_lshl_b32 s32, s26, 1
    s_add_u32 s31, s31, s32
    s_lshl_b32 s31, s31, 6
    s_add_u32 s31, s31, s38
    s_lshl_b32 s31, s31, 10
    s_add_u32 s31, s31, 2097152
    v_mul_f32 v96, v96, v97
    v_sub_f32 v96, 0, v96
    v_fma_f32 v48, v48, v97, v96
    v_fma_f32 v49, v49, v97, v96
    v_fma_f32 v50, v50, v97, v96
    v_fma_f32 v51, v51, v97, v96
    v_fma_f32 v52, v52, v97, v96
    v_fma_f32 v53, v53, v97, v96
    v_fma_f32 v54, v54, v97, v96
    v_fma_f32 v55, v55, v97, v96
    v_fma_f32 v56, v56, v97, v96
    v_fma_f32 v57, v57, v97, v96
    v_fma_f32 v58, v58, v97, v96
    v_fma_f32 v59, v59, v97, v96
    v_fma_f32 v60, v60, v97, v96
    v_fma_f32 v61, v61, v97, v96
    v_fma_f32 v62, v62, v97, v96
    v_fma_f32 v63, v63, v97, v96
    v_cvt_pk_bf16_f32 v72, v48, v49
    v_cvt_pk_bf16_f32 v73, v50, v51
    v_cvt_pk_bf16_f32 v74, v52, v53
    v_cvt_pk_bf16_f32 v75, v54, v55
    v_cvt_pk_bf16_f32 v76, v56, v57
    v_cvt_pk_bf16_f32 v77, v58, v59
    v_cvt_pk_bf16_f32 v78, v60, v61
    v_cvt_pk_bf16_f32 v79, v62, v63
    v_mfma_f32_32x32x16_bf16 v[80:95], v[72:75], v[24:27], 0
    s_nop 0
    v_mfma_f32_32x32x16_bf16 v[80:95], v[76:79], v[28:31], v[80:95]
    s_nop 11
    v_cvt_pk_bf16_f32 v72, v80, v81
    v_cvt_pk_bf16_f32 v73, v82, v83
    v_cvt_pk_bf16_f32 v74, v84, v85
    v_cvt_pk_bf16_f32 v75, v86, v87
    v_cvt_pk_bf16_f32 v76, v88, v89
    v_cvt_pk_bf16_f32 v77, v90, v91
    v_cvt_pk_bf16_f32 v78, v92, v93
    v_cvt_pk_bf16_f32 v79, v94, v95
    v_permlane32_swap_b32 v72, v74
    v_permlane32_swap_b32 v73, v75
    v_permlane32_swap_b32 v76, v78
    v_permlane32_swap_b32 v77, v79
    buffer_store_dwordx4 v[72:75], v3, s[12:15], s31 offen sc1
    buffer_store_dwordx4 v[76:79], v3, s[12:15], s31 offen offset:512 sc1
L_n_skip:
    s_cmp_eq_u32 s87, 1
    s_cbranch_scc1 L_A_hend
L_A_d1:
    s_cmp_lt_u32 s28, 8
    s_cselect_b32 s31, 0, 1
    s_cmp_eq_u32 s26, s31
    s_cbranch_scc0 L_A_d2
    s_and_b32 s40, s78, 7
    s_lshl_b32 s40, s40, 0
    s_and_b32 s31, s79, 3
    s_mul_i32 s31, s31, 0
    s_add_u32 s40, s40, s31
    s_and_b32 s40, s40, 31
    s_lshl_b32 s31, s78, 18
    s_add_u32 s16, s88, s31
    s_addc_u32 s17, s89, 0
    s_and_b32 s17, s17, 0xffff
    s_mov_b32 s18, 262144
    s_mov_b32 s19, 0x20000
    v_lshrrev_b32 v38, 3, v8
    v_and_b32 v39, 7, v8
    v_lshrrev_b32 v201, 1, v38
    v_xor_b32 v39, v39, v201
    v_lshlrev_b32 v39, 4, v39
    v_lshl_add_u32 v200, v38, 12, v39
    v_add_u32 v201, 32768, v200
    v_xor_b32 v201, 64, v201
    v_add_u32 v202, 65536, v200
    v_add_u32 v203, 98304, v200
    v_xor_b32 v203, 64, v203
    v_add_u32 v204, 131072, v200
    v_add_u32 v205, 163840, v200
    v_xor_b32 v205, 64, v205
    v_add_u32 v206, 196608, v200
    v_add_u32 v207, 229376, v200
    v_xor_b32 v207, 64, v207
    s_lshl_b32 s34, s25, 1
    s_add_u32 s48, s40, s34
    s_lshl_b32 s47, s34, 13
    s_and_b32 s48, s48, 31
    s_lshl_b32 s48, s48, 7
    s_mov_b32 m0, s47
    s_nop 0
    buffer_load_dwordx4 v200, s[16:19], s48 offen lds
    s_add_u32 m0, s47, 1024
    s_nop 0
    buffer_load_dwordx4 v201, s[16:19], s48 offen lds
    s_add_u32 m0, s47, 2048
    s_nop 0
    buffer_load_dwordx4 v202, s[16:19], s48 offen lds
    s_add_u32 m0, s47, 3072
    s_nop 0
    buffer_load_dwordx4 v203, s[16:19], s48 offen lds
    s_add_u32 m0, s47, 4096
    s_nop 0
    buffer_load_dwordx4 v204, s[16:19], s48 offen lds
    s_add_u32 m0, s47, 5120
    s_nop 0
    buffer_load_dwordx4 v205, s[16:19], s48 offen lds
    s_add_u32 m0, s47, 6144
    s_nop 0
    buffer_load_dwordx4 v206, s[16:19], s48 offen lds
    s_add_u32 m0, s47, 7168
    s_nop 0
    buffer_load_dwordx4 v207, s[16:19], s48 offen lds
    s_add_u32 s47, s47, 8192
    s_and_b32 s47, s47, 65535
    s_add_u32 s48, s48, 128
    s_and_b32 s48, s48, 0xfff
    s_cmp_eq_u32 s25, 3
    s_cbranch_scc1 L_tw_1
    s_mov_b32 m0, s47
    s_nop 0
    buffer_load_dwordx4 v200, s[16:19], s48 offen lds
    s_add_u32 m0, s47, 1024
    s_nop 0
    buffer_load_dwordx4 v201, s[16:19], s48 offen lds
    s_add_u32 m0, s47, 2048
    s_nop 0
    buffer_load_dwordx4 v202, s[16:19], s48 offen lds
    s_add_u32 m0, s47, 3072
    s_nop 0
    buffer_load_dwordx4 v203, s[16:19], s48 offen lds
    s_add_u32 m0, s47, 4096
    s_nop 0
    buffer_load_dwordx4 v204, s[16:19], s48 offen lds
    s_add_u32 m0, s47, 5120
    s_nop 0
    buffer_load_dwordx4 v205, s[16:19], s48 offen lds
    s_add_u32 m0, s47, 6144
    s_nop 0
    buffer_load_dwordx4 v206, s[16:19], s48 offen lds
    s_add_u32 m0, s47, 7168
    s_nop 0
    buffer_load_dwordx4 v207, s[16:19], s48 offen lds
    s_add_u32 s47, s47, 8192
    s_and_b32 s47, s47, 65535
    s_add_u32 s48, s48, 128
    s_and_b32 s48, s48, 0xfff
L_tw_1:
    v_mov_b32 v72, -1
    v_mov_b32 v73, -1
    v_mov_b32 v74, -1
    v_mov_b32 v75, -1
    s_mul_i32 s31, s78, 112
    s_mul_i32 s32, s79, 7
    s_add_u32 s31, s31, s32
    s_lshl_b32 s34, s25, 2
    s_add_u32 s32, s34, 0
    s_cmp_ge_u32 s32, 7
    s_cselect_b32 s33, 49, 0
    s_add_u32 s33, s33, s32
    s_add_u32 s33, s33, s31
    s_lshl_b32 s33, s33, 10
    s_add_u32 s33, s33, 12582912
    buffer_store_dwordx4 v[72:75], v1, s[12:15], s33 offen sc1
    s_add_u32 s32, s34, 1
    s_cmp_ge_u32 s32, 7
    s_cselect_b32 s33, 49, 0
    s_add_u32 s33, s33, s32
    s_add_u32 s33, s33, s31
    s_lshl_b32 s33, s33, 10
    s_add_u32 s33, s33, 12582912
    buffer_store_dwordx4 v[72:75], v1, s[12:15], s33 offen sc1
    s_add_u32 s32, s34, 2
    s_cmp_ge_u32 s32, 7
    s_cselect_b32 s33, 49, 0
    s_add_u32 s33, s33, s32
    s_add_u32 s33, s33, s31
    s_lshl_b32 s33, s33, 10
    s_add_u32 s33, s33, 12582912
    s_lshl_b32 s60, s2, 10
    s_add_u32 s60, s60, 1179648
    s_cmp_ge_u32 s2, 32
    s_cselect_b32 s60, 2130706432, s60
    s_cmp_eq_u32 s25, 3
    s_cselect_b32 s33, s60, s33
    buffer_store_dwordx4 v[72:75], v1, s[12:15], s33 offen sc1
    s_add_u32 s32, s34, 3
    s_cmp_ge_u32 s32, 7
    s_cselect_b32 s33, 49, 0
    s_add_u32 s33, s33, s32
    s_add_u32 s33, s33, s31
    s_lshl_b32 s33, s33, 10
    s_add_u32 s33, s33, 12582912
    s_lshl_b32 s60, s2, 10
    s_add_u32 s60, s60, 1179648
    s_cmp_ge_u32 s2, 32
    s_cselect_b32 s60, 2130706432, s60
    s_mov_b32 s60, 2130706432
    s_cmp_eq_u32 s25, 3
    s_cselect_b32 s33, s60, s33
    buffer_store_dwordx4 v[72:75], v1, s[12:15], s33 offen sc1
    s_waitcnt vmcnt(4)
L_A_d2:
    s_waitcnt lgkmcnt(0)
    s_barrier
    s_cmp_lt_u32 s28, 8
    s_cbranch_scc0 L_A_fin
    v_lshlrev_b32 v96, 2, v8
    s_lshl_b32 s31, s24, 8
    s_add_u32 s31, s31, 81920
    v_add_u32 v96, s31, v96
    ds_read_b32 v98, v96 offset:0
    ds_read_b32 v99, v96 offset:2048
    ds_read_b32 v100, v96 offset:4096
    ds_read_b32 v101, v96 offset:6144
    ds_read_b32 v102, v96 offset:8192
    ds_read_b32 v103, v96 offset:10240
    ds_read_b32 v104, v96 offset:12288
    ds_read_b32 v105, v96 offset:14336
    v_lshrrev_b32 v97, 5, v8
    v_lshlrev_b32 v97, 10, v97
    v_and_b32 v106, 31, v8
    v_lshl_add_u32 v97, v106, 2, v97
    v_add_u32 v97, 65536, v97
    ds_read_b32 v80, v97 offset:0
    ds_read_b32 v81, v97 offset:128
    ds_read_b32 v82, v97 offset:256
    ds_read_b32 v83, v97 offset:384
    ds_read_b32 v84, v97 offset:512
    ds_read_b32 v85, v97 offset:640
    ds_read_b32 v86, v97 offset:768
    ds_read_b32 v87, v97 offset:896
    v_lshrrev_b32 v107, 4, v8
    v_and_b32 v107, 1, v107
    v_mul_u32_u24 v107, 1152, v107
    v_lshrrev_b32 v108, 5, v8
    v_lshlrev_b32 v108, 4, v108
    v_and_b32 v109, 15, v8
    v_add_u32 v108, v108, v109
    v_lshl_add_u32 v107, v108, 2, v107
    s_lshl_b32 s31, s27, 5
    s_lshl_b32 s32, s28, 2
    s_add_u32 s31, s31, s32
    s_mul_i32 s31, s31, 1152
    s_add_u32 s33, s31, 524288
    s_lshl_b32 s32, s24, 7
    s_add_u32 s31, s33, s32
    s_add_u32 s32, s31, 2304
    s_waitcnt lgkmcnt(0)
    v_add_f32 v98, v98, v99
    v_add_f32 v100, v100, v101
    v_add_f32 v98, v98, v100
    buffer_store_dword v98, v107, s[12:15], s31 offen sc1
    v_add_f32 v102, v102, v103
    v_add_f32 v104, v104, v105
    v_add_f32 v102, v102, v104
    buffer_store_dword v102, v107, s[12:15], s32 offen sc1
    v_add_f32 v80, v80, v81
    v_add_f32 v82, v82, v83
    v_add_f32 v84, v84, v85
    v_add_f32 v86, v86, v87
    v_add_f32 v80, v80, v82
    v_add_f32 v84, v84, v86
    v_add_f32 v80, v80, v84
    v_lshrrev_b32 v107, 4, v8
    v_mul_u32_u24 v107, 1152, v107
    v_lshrrev_b32 v108, 2, v109
    v_and_b32 v108, 1, v108
    v_lshlrev_b32 v108, 3, v108
    v_and_b32 v110, 3, v109
    v_add_u32 v108, v108, v110
    v_lshrrev_b32 v110, 3, v109
    v_lshl_add_u32 v108, v110, 2, v108
    v_lshl_add_u32 v107, v108, 2, v107
    s_add_u32 s33, s33, 1024
    s_cmp_lg_u32 s24, 0
    s_cselect_b32 s33, 2130706432, s33
    buffer_store_dword v80, v107, s[12:15], s33 offen sc1
L_A_fin:
    s_lshr_b32 s50, s24, 2
    s_and_b32 s51, s24, 3
    s_lshl_b32 s52, s78, 1
    s_add_u32 s52, s52, s50
    s_mov_b32 s41, 0
    s_cmp_eq_u32 s24, 7
    s_cbranch_scc1 L_B_prod
    s_and_b32 s40, s78, 7
    s_lshl_b32 s40, s40, 0
    s_and_b32 s31, s79, 3
    s_mul_i32 s31, s31, 0
    s_add_u32 s40, s40, s31
    s_and_b32 s40, s40, 31
    s_mul_i32 s42, s79, 7
    s_add_u32 s42, s42, s24
    s_lshl_b32 s42, s42, 16
    s_add_u32 s42, s42, 2097152
    s_add_u32 s8, s12, s42
    s_addc_u32 s9, s13, 0
    s_mov_b32 s10, 65536
    s_mov_b32 s11, 0x20000
    s_lshl_b32 s44, s40, 11
    buffer_load_dwordx4 v[128:131], v1, s[8:11], s44 offen sc1
    buffer_load_dwordx4 v[132:135], v1, s[8:11], s44 offen offset:1024 sc1
    s_add_u32 s44, s44, 2048
    s_and_b32 s44, s44, 0xffff
    buffer_load_dwordx4 v[136:139], v1, s[8:11], s44 offen sc1
    buffer_load_dwordx4 v[140:143], v1, s[8:11], s44 offen offset:1024 sc1
    s_add_u32 s44, s44, 2048
    s_and_b32 s44, s44, 0xffff
    buffer_load_dwordx4 v[144:147], v1, s[8:11], s44 offen sc1
    buffer_load_dwordx4 v[148:151], v1, s[8:11], s44 offen offset:1024 sc1
    s_add_u32 s44, s44, 2048
    s_and_b32 s44, s44, 0xffff
    buffer_load_dwordx4 v[152:155], v1, s[8:11], s44 offen sc1
    buffer_load_dwordx4 v[156:159], v1, s[8:11], s44 offen offset:1024 sc1
    s_add_u32 s44, s44, 2048
    s_and_b32 s44, s44, 0xffff
    v_and_b32 v96, 15, v8
    v_lshrrev_b32 v97, 4, v8
    v_lshrrev_b32 v98, 1, v96
    v_xor_b32 v97, v97, v98
    v_lshlrev_b32 v97, 4, v97
    v_lshl_add_u32 v40, v96, 7, v97
    v_xor_b32 v41, 64, v40
    v_mov_b32 v112, 0
    v_mov_b32 v113, 0
    v_mov_b32 v114, 0
    v_mov_b32 v115, 0
    v_mov_b32 v116, 0
    v_mov_b32 v117, 0
    v_mov_b32 v118, 0
    v_mov_b32 v119, 0
    v_mov_b32 v120, 0
    v_mov_b32 v121, 0
    v_mov_b32 v122, 0
    v_mov_b32 v123, 0
    v_mov_b32 v124, 0
    v_mov_b32 v125, 0
    v_mov_b32 v126, 0
    v_mov_b32 v127, 0
    s_barrier
    ds_read_b128 v[160:163], v40 offset:0
    ds_read_b128 v[164:167], v40 offset:2048
    ds_read_b128 v[168:171], v40 offset:4096
    ds_read_b128 v[172:175], v40 offset:6144
    ds_read_b128 v[176:179], v41 offset:0
    ds_read_b128 v[180:183], v41 offset:2048
    ds_read_b128 v[184:187], v41 offset:4096
    ds_read_b128 v[188:191], v41 offset:6144
L_B_clL:
    s_waitcnt lgkmcnt(0)
    s_barrier
    ds_read_b128 v[192:195], v40 offset:8192
    ds_read_b128 v[196:199], v40 offset:10240
    ds_read_b128 v[200:203], v40 offset:12288
    ds_read_b128 v[204:207], v40 offset:14336
    ds_read_b128 v[208:211], v41 offset:8192
    ds_read_b128 v[212:215], v41 offset:10240
    ds_read_b128 v[216:219], v41 offset:12288
    ds_read_b128 v[220:223], v41 offset:14336
    s_waitcnt vmcnt(6)
    v_max3_u32 v96, v128, v129, v130
    v_max3_u32 v97, v131, v132, v133
    v_max3_u32 v96, v96, v134, v135
    v_max_u32 v96, v96, v97
    v_cmp_eq_u32 vcc, -1, v96
    s_nop 3
    s_cbranch_vccnz L_B_rtL0
L_B_okL0:
    v_mfma_f32_16x16x32_bf16 v[112:115], v[128:131], v[160:163], v[112:115]
    v_mfma_f32_16x16x32_bf16 v[116:119], v[128:131], v[164:167], v[116:119]
    v_mfma_f32_16x16x32_bf16 v[120:123], v[128:131], v[168:171], v[120:123]
    v_mfma_f32_16x16x32_bf16 v[124:127], v[128:131], v[172:175], v[124:127]
    v_mfma_f32_16x16x32_bf16 v[112:115], v[132:135], v[176:179], v[112:115]
    v_mfma_f32_16x16x32_bf16 v[116:119], v[132:135], v[180:183], v[116:119]
    v_mfma_f32_16x16x32_bf16 v[120:123], v[132:135], v[184:187], v[120:123]
    v_mfma_f32_16x16x32_bf16 v[124:127], v[132:135], v[188:191], v[124:127]
    buffer_load_dwordx4 v[128:131], v1, s[8:11], s44 offen sc1
    buffer_load_dwordx4 v[132:135], v1, s[8:11], s44 offen offset:1024 sc1
    s_add_u32 s44, s44, 2048
    s_and_b32 s44, s44, 0xffff
    s_waitcnt lgkmcnt(0)
    ds_read_b128 v[160:163], v40 offset:16384
    ds_read_b128 v[164:167], v40 offset:18432
    ds_read_b128 v[168:171], v40 offset:20480
    ds_read_b128 v[172:175], v40 offset:22528
    ds_read_b128 v[176:179], v41 offset:16384
    ds_read_b128 v[180:183], v41 offset:18432
    ds_read_b128 v[184:187], v41 offset:20480
    ds_read_b128 v[188:191], v41 offset:22528
    s_waitcnt vmcnt(6)
    v_max3_u32 v96, v136, v137, v138
    v_max3_u32 v97, v139, v140, v141
    v_max3_u32 v96, v96, v142, v143
    v_max_u32 v96, v96, v97
    v_cmp_eq_u32 vcc, -1, v96
    s_nop 3
    s_cbranch_vccnz L_B_rtL1
L_B_okL1:
    v_mfma_f32_16x16x32_bf16 v[112:115], v[136:139], v[192:195], v[112:115]
    v_mfma_f32_16x16x32_bf16 v[116:119], v[136:139], v[196:199], v[116:119]
    v_mfma_f32_16x16x32_bf16 v[120:123], v[136:139], v[200:203], v[120:123]
    v_mfma_f32_16x16x32_bf16 v[124:127], v[136:139], v[204:207], v[124:127]
    v_mfma_f32_16x16x32_bf16 v[112:115], v[140:143], v[208:211], v[112:115]
    v_mfma_f32_16x16x32_bf16 v[116:119], v[140:143], v[212:215], v[116:119]
    v_mfma_f32_16x16x32_bf16 v[120:123], v[140:143], v[216:219], v[120:123]
    v_mfma_f32_16x16x32_bf16 v[124:127], v[140:143], v[220:223], v[124:127]
    buffer_load_dwordx4 v[136:139], v1, s[8:11], s44 offen sc1
    buffer_load_dwordx4 v[140:143], v1, s[8:11], s44 offen offset:1024 sc1
    s_add_u32 s44, s44, 2048
    s_and_b32 s44, s44, 0xffff
    s_waitcnt lgkmcnt(0)
    s_barrier
    ds_read_b128 v[192:195], v40 offset:24576
    ds_read_b128 v[196:199], v40 offset:26624
    ds_read_b128 v[200:203], v40 offset:28672
    ds_read_b128 v[204:207], v40 offset:30720
    ds_read_b128 v[208:211], v41 offset:24576
    ds_read_b128 v[212:215], v41 offset:26624
    ds_read_b128 v[216:219], v41 offset:28672
    ds_read_b128 v[220:223], v41 offset:30720
    s_waitcnt vmcnt(6)
    v_max3_u32 v96, v144, v145, v146
    v_max3_u32 v97, v147, v148, v149
    v_max3_u32 v96, v96, v150, v151
    v_max_u32 v96, v96, v97
    v_cmp_eq_u32 vcc, -1, v96
    s_nop 3
    s_cbranch_vccnz L_B_rtL2
L_B_okL2:
    v_mfma_f32_16x16x32_bf16 v[112:115], v[144:147], v[160:163], v[112:115]
    v_mfma_f32_16x16x32_bf16 v[116:119], v[144:147], v[164:167], v[116:119]
    v_mfma_f32_16x16x32_bf16 v[120:123], v[144:147], v[168:171], v[120:123]
    v_mfma_f32_16x16x32_bf16 v[124:127], v[144:147], v[172:175], v[124:127]
    v_mfma_f32_16x16x32_bf16 v[112:115], v[148:151], v[176:179], v[112:115]
    v_mfma_f32_16x16x32_bf16 v[116:119], v[148:151], v[180:183], v[116:119]
    v_mfma_f32_16x16x32_bf16 v[120:123], v[148:151], v[184:187], v[120:123]
    v_mfma_f32_16x16x32_bf16 v[124:127], v[148:151], v[188:191], v[124:127]
    buffer_load_dwordx4 v[144:147], v1, s[8:11], s44 offen sc1
    buffer_load_dwordx4 v[148:151], v1, s[8:11], s44 offen offset:1024 sc1
    s_add_u32 s44, s44, 2048
    s_and_b32 s44, s44, 0xffff
    s_waitcnt lgkmcnt(0)
    ds_read_b128 v[160:163], v40 offset:32768
    ds_read_b128 v[164:167], v40 offset:34816
    ds_read_b128 v[168:171], v40 offset:36864
    ds_read_b128 v[172:175], v40 offset:38912
    ds_read_b128 v[176:179], v41 offset:32768
    ds_read_b128 v[180:183], v41 offset:34816
    ds_read_b128 v[184:187], v41 offset:36864
    ds_read_b128 v[188:191], v41 offset:38912
    s_waitcnt vmcnt(6)
    v_max3_u32 v96, v152, v153, v154
    v_max3_u32 v97, v155, v156, v157
    v_max3_u32 v96, v96, v158, v159
    v_max_u32 v96, v96, v97
    v_cmp_eq_u32 vcc, -1, v96
    s_nop 3
    s_cbranch_vccnz L_B_rtL3
L_B_okL3:
    v_mfma_f32_16x16x32_bf16 v[112:115], v[152:155], v[192:195], v[112:115]
    v_mfma_f32_16x16x32_bf16 v[116:119], v[152:155], v[196:199], v[116:119]
    v_mfma_f32_16x16x32_bf16 v[120:123], v[152:155], v[200:203], v[120:123]
    v_mfma_f32_16x16x32_bf16 v[124:127], v[152:155], v[204:207], v[124:127]
    v_mfma_f32_16x16x32_bf16 v[112:115], v[156:159], v[208:211], v[112:115]
    v_mfma_f32_16x16x32_bf16 v[116:119], v[156:159], v[212:215], v[116:119]
    v_mfma_f32_16x16x32_bf16 v[120:123], v[156:159], v[216:219], v[120:123]
    v_mfma_f32_16x16x32_bf16 v[124:127], v[156:159], v[220:223], v[124:127]
    buffer_load_dwordx4 v[152:155], v1, s[8:11], s44 offen sc1
    buffer_load_dwordx4 v[156:159], v1, s[8:11], s44 offen offset:1024 sc1
    s_add_u32 s44, s44, 2048
    s_and_b32 s44, s44, 0xffff
    s_waitcnt lgkmcnt(0)
    s_barrier
    ds_read_b128 v[192:195], v40 offset:40960
    ds_read_b128 v[196:199], v40 offset:43008
    ds_read_b128 v[200:203], v40 offset:45056
    ds_read_b128 v[204:207], v40 offset:47104
    ds_read_b128 v[208:211], v41 offset:40960
    ds_read_b128 v[212:215], v41 offset:43008
    ds_read_b128 v[216:219], v41 offset:45056
    ds_read_b128 v[220:223], v41 offset:47104
    s_waitcnt vmcnt(6)
    v_max3_u32 v96, v128, v129, v130
    v_max3_u32 v97, v131, v132, v133
    v_max3_u32 v96, v96, v134, v135
    v_max_u32 v96, v96, v97
    v_cmp_eq_u32 vcc, -1, v96
    s_nop 3
    s_cbranch_vccnz L_B_rtL4
L_B_okL4:
    v_mfma_f32_16x16x32_bf16 v[112:115], v[128:131], v[160:163], v[112:115]
    v_mfma_f32_16x16x32_bf16 v[116:119], v[128:131], v[164:167], v[116:119]
    v_mfma_f32_16x16x32_bf16 v[120:123], v[128:131], v[168:171], v[120:123]
    v_mfma_f32_16x16x32_bf16 v[124:127], v[128:131], v[172:175], v[124:127]
    v_mfma_f32_16x16x32_bf16 v[112:115], v[132:135], v[176:179], v[112:115]
    v_mfma_f32_16x16x32_bf16 v[116:119], v[132:135], v[180:183], v[116:119]
    v_mfma_f32_16x16x32_bf16 v[120:123], v[132:135], v[184:187], v[120:123]
    v_mfma_f32_16x16x32_bf16 v[124:127], v[132:135], v[188:191], v[124:127]
    s_cmp_eq_u32 s41, 24
    s_cbranch_scc1 L_B_x_5
    buffer_load_dwordx4 v[128:131], v1, s[8:11], s44 offen sc1
    buffer_load_dwordx4 v[132:135], v1, s[8:11], s44 offen offset:1024 sc1
    s_add_u32 s44, s44, 2048
    s_and_b32 s44, s44, 0xffff
L_B_x_6:
    s_waitcnt lgkmcnt(0)
    ds_read_b128 v[160:163], v40 offset:49152
    ds_read_b128 v[164:167], v40 offset:51200
    ds_read_b128 v[168:171], v40 offset:53248
    ds_read_b128 v[172:175], v40 offset:55296
    ds_read_b128 v[176:179], v41 offset:49152
    ds_read_b128 v[180:183], v41 offset:51200
    ds_read_b128 v[184:187], v41 offset:53248
    ds_read_b128 v[188:191], v41 offset:55296
    s_cmp_eq_u32 s41, 24
    s_cbranch_scc1 L_B_w_7
    s_waitcnt vmcnt(6)
    s_branch L_B_w_8
L_B_w_7:
    s_waitcnt vmcnt(7)
L_B_w_8:
    v_max3_u32 v96, v136, v137, v138
    v_max3_u32 v97, v139, v140, v141
    v_max3_u32 v96, v96, v142, v143
    v_max_u32 v96, v96, v97
    v_cmp_eq_u32 vcc, -1, v96
    s_nop 3
    s_cbranch_vccnz L_B_rtL5
L_B_okL5:
    v_mfma_f32_16x16x32_bf16 v[112:115], v[136:139], v[192:195], v[112:115]
    v_mfma_f32_16x16x32_bf16 v[116:119], v[136:139], v[196:199], v[116:119]
    v_mfma_f32_16x16x32_bf16 v[120:123], v[136:139], v[200:203], v[120:123]
    v_mfma_f32_16x16x32_bf16 v[124:127], v[136:139], v[204:207], v[124:127]
    v_mfma_f32_16x16x32_bf16 v[112:115], v[140:143], v[208:211], v[112:115]
    v_mfma_f32_16x16x32_bf16 v[116:119], v[140:143], v[212:215], v[116:119]
    v_mfma_f32_16x16x32_bf16 v[120:123], v[140:143], v[216:219], v[120:123]
    v_mfma_f32_16x16x32_bf16 v[124:127], v[140:143], v[220:223], v[124:127]
    s_cmp_eq_u32 s41, 24
    s_cbranch_scc1 L_B_x_9
    buffer_load_dwordx4 v[136:139], v1, s[8:11], s44 offen sc1
    buffer_load_dwordx4 v[140:143], v1, s[8:11], s44 offen offset:1024 sc1
    s_add_u32 s44, s44, 2048
    s_and_b32 s44, s44, 0xffff
L_B_x_10:
    s_waitcnt lgkmcnt(0)
    s_barrier
    ds_read_b128 v[192:195], v40 offset:57344
    ds_read_b128 v[196:199], v40 offset:59392
    ds_read_b128 v[200:203], v40 offset:61440
    ds_read_b128 v[204:207], v40 offset:63488
    ds_read_b128 v[208:211], v41 offset:57344
    ds_read_b128 v[212:215], v41 offset:59392
    ds_read_b128 v[216:219], v41 offset:61440
    ds_read_b128 v[220:223], v41 offset:63488
    s_cmp_eq_u32 s41, 24
    s_cbranch_scc1 L_B_w_11
    s_waitcnt vmcnt(6)
    s_branch L_B_w_12
L_B_w_11:
    s_waitcnt vmcnt(9)
L_B_w_12:
    v_max3_u32 v96, v144, v145, v146
    v_max3_u32 v97, v147, v148, v149
    v_max3_u32 v96, v96, v150, v151
    v_max_u32 v96, v96, v97
    v_cmp_eq_u32 vcc, -1, v96
    s_nop 3
    s_cbranch_vccnz L_B_rtL6
L_B_okL6:
    v_mfma_f32_16x16x32_bf16 v[112:115], v[144:147], v[160:163], v[112:115]
    v_mfma_f32_16x16x32_bf16 v[116:119], v[144:147], v[164:167], v[116:119]
    v_mfma_f32_16x16x32_bf16 v[120:123], v[144:147], v[168:171], v[120:123]
    v_mfma_f32_16x16x32_bf16 v[124:127], v[144:147], v[172:175], v[124:127]
    v_mfma_f32_16x16x32_bf16 v[112:115], v[148:151], v[176:179], v[112:115]
    v_mfma_f32_16x16x32_bf16 v[116:119], v[148:151], v[180:183], v[116:119]
    v_mfma_f32_16x16x32_bf16 v[120:123], v[148:151], v[184:187], v[120:123]
    v_mfma_f32_16x16x32_bf16 v[124:127], v[148:151], v[188:191], v[124:127]
    s_cmp_eq_u32 s41, 24
    s_cbranch_scc1 L_B_x_13
    buffer_load_dwordx4 v[144:147], v1, s[8:11], s44 offen sc1
    buffer_load_dwordx4 v[148:151], v1, s[8:11], s44 offen offset:1024 sc1
    s_add_u32 s44, s44, 2048
    s_and_b32 s44, s44, 0xffff
L_B_x_14:
    s_waitcnt lgkmcnt(0)
    ds_read_b128 v[160:163], v40 offset:0
    ds_read_b128 v[164:167], v40 offset:2048
    ds_read_b128 v[168:171], v40 offset:4096
    ds_read_b128 v[172:175], v40 offset:6144
    ds_read_b128 v[176:179], v41 offset:0
    ds_read_b128 v[180:183], v41 offset:2048
    ds_read_b128 v[184:187], v41 offset:4096
    ds_read_b128 v[188:191], v41 offset:6144
    s_cmp_eq_u32 s41, 24
    s_cbranch_scc1 L_B_w_15
    s_waitcnt vmcnt(6)
    s_branch L_B_w_16
L_B_w_15:
    s_waitcnt vmcnt(11)
L_B_w_16:
    v_max3_u32 v96, v152, v153, v154
    v_max3_u32 v97, v155, v156, v157
    v_max3_u32 v96, v96, v158, v159
    v_max_u32 v96, v96, v97
    v_cmp_eq_u32 vcc, -1, v96
    s_nop 3
    s_cbranch_vccnz L_B_rtL7
L_B_okL7:
    v_mfma_f32_16x16x32_bf16 v[112:115], v[152:155], v[192:195], v[112:115]
    v_mfma_f32_16x16x32_bf16 v[116:119], v[152:155], v[196:199], v[116:119]
    v_mfma_f32_16x16x32_bf16 v[120:123], v[152:155], v[200:203], v[120:123]
    v_mfma_f32_16x16x32_bf16 v[124:127], v[152:155], v[204:207], v[124:127]
    v_mfma_f32_16x16x32_bf16 v[112:115], v[156:159], v[208:211], v[112:115]
    v_mfma_f32_16x16x32_bf16 v[116:119], v[156:159], v[212:215], v[116:119]
    v_mfma_f32_16x16x32_bf16 v[120:123], v[156:159], v[216:219], v[120:123]
    v_mfma_f32_16x16x32_bf16 v[124:127], v[156:159], v[220:223], v[124:127]
    s_cmp_eq_u32 s41, 24
    s_cbranch_scc1 L_B_x_17
    buffer_load_dwordx4 v[152:155], v1, s[8:11], s44 offen sc1
    buffer_load_dwordx4 v[156:159], v1, s[8:11], s44 offen offset:1024 sc1
    s_add_u32 s44, s44, 2048
    s_and_b32 s44, s44, 0xffff
L_B_x_18:
    s_add_u32 s41, s41, 8
    s_cmp_lt_u32 s41, 32
    s_cbranch_scc1 L_B_clL
    s_branch L_B_epi
L_B_x_5:
    s_mul_i32 s31, s78, 112
    s_mul_i32 s32, s79, 7
    s_add_u32 s31, s31, s32
    s_add_u32 s31, s31, s24
    s_lshl_b32 s31, s31, 10
    s_add_u32 s55, s31, 12582912
    s_add_u32 s31, s31, 6291456
    s_add_u32 s32, s31, 57344
    buffer_load_dwordx4 v[64:67], v1, s[12:15], s31 offen sc1
    buffer_load_dwordx4 v[68:71], v1, s[12:15], s32 offen sc1
    s_mov_b32 s16, s90
    s_and_b32 s17, s91, 0xffff
    s_mov_b32 s18, 4096
    s_mov_b32 s19, 0x20000
    v_lshlrev_b32 v98, 1, v8
    s_lshl_b32 s31, s78, 7
    buffer_load_ushort v76, v98, s[16:19], s31 offen
    s_branch L_B_x_6
L_B_x_9:
    s_lshl_b32 s31, s52, 5
    s_lshl_b32 s32, s51, 3
    s_add_u32 s31, s31, s32
    s_add_u32 s31, s31, 0
    s_lshl_b32 s31, s31, 10
    s_add_u32 s31, s31, 10485760
    buffer_load_dwordx4 v[224:227], v1, s[12:15], s31 offen offset:0 sc1
    buffer_load_dwordx4 v[228:231], v1, s[12:15], s31 offen offset:1024 sc1
    buffer_load_dwordx4 v[232:235], v1, s[12:15], s31 offen offset:2048 sc1
    buffer_load_dwordx4 v[236:239], v1, s[12:15], s31 offen offset:3072 sc1
    s_branch L_B_x_10
L_B_x_13:
    s_lshl_b32 s31, s52, 5
    s_lshl_b32 s32, s51, 3
    s_add_u32 s31, s31, s32
    s_add_u32 s31, s31, 4
    s_lshl_b32 s31, s31, 10
    s_add_u32 s31, s31, 10485760
    buffer_load_dwordx4 v[240:243], v1, s[12:15], s31 offen offset:0 sc1
    buffer_load_dwordx4 v[244:247], v1, s[12:15], s31 offen offset:1024 sc1
    buffer_load_dwordx4 v[248:251], v1, s[12:15], s31 offen offset:2048 sc1
    buffer_load_dwordx4 v[252:255], v1, s[12:15], s31 offen offset:3072 sc1
    s_branch L_B_x_14
L_B_x_17:
    s_branch L_B_x_18
L_B_rtL0:
    s_mov_b32 s80, 0
    s_add_u32 s31, s41, 0
    s_add_u32 s31, s31, s40
    s_and_b32 s31, s31, 31
    s_lshl_b32 s31, s31, 11
    s_add_u32 s31, s31, s42
L_B_rtL0_l:
    buffer_load_dwordx4 v[128:131], v1, s[12:15], s31 offen sc1
    buffer_load_dwordx4 v[132:135], v1, s[12:15], s31 offen offset:1024 sc1
    s_waitcnt vmcnt(0)
    v_max3_u32 v96, v128, v129, v130
    v_max3_u32 v97, v131, v132, v133
    v_max3_u32 v96, v96, v134, v135
    v_max_u32 v96, v96, v97
    v_cmp_eq_u32 vcc, -1, v96
    s_add_u32 s80, s80, 1
    s_cmp_gt_u32 s80, 200000
    s_cbranch_scc1 L_B_okL0
    s_nop 0
    s_cbranch_vccnz L_B_rtL0_l
    s_branch L_B_okL0
L_B_rtL1:
    s_mov_b32 s80, 0
    s_add_u32 s31, s41, 1
    s_add_u32 s31, s31, s40
    s_and_b32 s31, s31, 31
    s_lshl_b32 s31, s31, 11
    s_add_u32 s31, s31, s42
L_B_rtL1_l:
    buffer_load_dwordx4 v[136:139], v1, s[12:15], s31 offen sc1
    buffer_load_dwordx4 v[140:143], v1, s[12:15], s31 offen offset:1024 sc1
    s_waitcnt vmcnt(0)
    v_max3_u32 v96, v136, v137, v138
    v_max3_u32 v97, v139, v140, v141
    v_max3_u32 v96, v96, v142, v143
    v_max_u32 v96, v96, v97
    v_cmp_eq_u32 vcc, -1, v96
    s_add_u32 s80, s80, 1
    s_cmp_gt_u32 s80, 200000
    s_cbranch_scc1 L_B_okL1
    s_nop 0
    s_cbranch_vccnz L_B_rtL1_l
    s_branch L_B_okL1
L_B_rtL2:
    s_mov_b32 s80, 0
    s_add_u32 s31, s41, 2
    s_add_u32 s31, s31, s40
    s_and_b32 s31, s31, 31
    s_lshl_b32 s31, s31, 11
    s_add_u32 s31, s31, s42
L_B_rtL2_l:
    buffer_load_dwordx4 v[144:147], v1, s[12:15], s31 offen sc1
    buffer_load_dwordx4 v[148:151], v1, s[12:15], s31 offen offset:1024 sc1
    s_waitcnt vmcnt(0)
    v_max3_u32 v96, v144, v145, v146
    v_max3_u32 v97, v147, v148, v149
    v_max3_u32 v96, v96, v150, v151
    v_max_u32 v96, v96, v97
    v_cmp_eq_u32 vcc, -1, v96
    s_add_u32 s80, s80, 1
    s_cmp_gt_u32 s80, 200000
    s_cbranch_scc1 L_B_okL2
    s_nop 0
    s_cbranch_vccnz L_B_rtL2_l
    s_branch L_B_okL2
L_B_rtL3:
    s_mov_b32 s80, 0
    s_add_u32 s31, s41, 3
    s_add_u32 s31, s31, s40
    s_and_b32 s31, s31, 31
    s_lshl_b32 s31, s31, 11
    s_add_u32 s31, s31, s42
L_B_rtL3_l:
    buffer_load_dwordx4 v[152:155], v1, s[12:15], s31 offen sc1
    buffer_load_dwordx4 v[156:159], v1, s[12:15], s31 offen offset:1024 sc1
    s_waitcnt vmcnt(0)
    v_max3_u32 v96, v152, v153, v154
    v_max3_u32 v97, v155, v156, v157
    v_max3_u32 v96, v96, v158, v159
    v_max_u32 v96, v96, v97
    v_cmp_eq_u32 vcc, -1, v96
    s_add_u32 s80, s80, 1
    s_cmp_gt_u32 s80, 200000
    s_cbranch_scc1 L_B_okL3
    s_nop 0
    s_cbranch_vccnz L_B_rtL3_l
    s_branch L_B_okL3
L_B_rtL4:
    s_mov_b32 s80, 0
    s_add_u32 s31, s41, 4
    s_add_u32 s31, s31, s40
    s_and_b32 s31, s31, 31
    s_lshl_b32 s31, s31, 11
    s_add_u32 s31, s31, s42
L_B_rtL4_l:
    buffer_load_dwordx4 v[128:131], v1, s[12:15], s31 offen sc1
    buffer_load_dwordx4 v[132:135], v1, s[12:15], s31 offen offset:1024 sc1
    s_waitcnt vmcnt(0)
    v_max3_u32 v96, v128, v129, v130
    v_max3_u32 v97, v131, v132, v133
    v_max3_u32 v96, v96, v134, v135
    v_max_u32 v96, v96, v97
    v_cmp_eq_u32 vcc, -1, v96
    s_add_u32 s80, s80, 1
    s_cmp_gt_u32 s80, 200000
    s_cbranch_scc1 L_B_okL4
    s_nop 0
    s_cbranch_vccnz L_B_rtL4_l
    s_branch L_B_okL4
L_B_rtL5:
    s_mov_b32 s80, 0
    s_add_u32 s31, s41, 5
    s_add_u32 s31, s31, s40
    s_and_b32 s31, s31, 31
    s_lshl_b32 s31, s31, 11
    s_add_u32 s31, s31, s42
L_B_rtL5_l:
    buffer_load_dwordx4 v[136:139], v1, s[12:15], s31 offen sc1
    buffer_load_dwordx4 v[140:143], v1, s[12:15], s31 offen offset:1024 sc1
    s_waitcnt vmcnt(0)
    v_max3_u32 v96, v136, v137, v138
    v_max3_u32 v97, v139, v140, v141
    v_max3_u32 v96, v96, v142, v143
    v_max_u32 v96, v96, v97
    v_cmp_eq_u32 vcc, -1, v96
    s_add_u32 s80, s80, 1
    s_cmp_gt_u32 s80, 200000
    s_cbranch_scc1 L_B_okL5
    s_nop 0
    s_cbranch_vccnz L_B_rtL5_l
    s_branch L_B_okL5
L_B_rtL6:
    s_mov_b32 s80, 0
    s_add_u32 s31, s41, 6
    s_add_u32 s31, s31, s40
    s_and_b32 s31, s31, 31
    s_lshl_b32 s31, s31, 11
    s_add_u32 s31, s31, s42
L_B_rtL6_l:
    buffer_load_dwordx4 v[144:147], v1, s[12:15], s31 offen sc1
    buffer_load_dwordx4 v[148:151], v1, s[12:15], s31 offen offset:1024 sc1
    s_waitcnt vmcnt(0)
    v_max3_u32 v96, v144, v145, v146
    v_max3_u32 v97, v147, v148, v149
    v_max3_u32 v96, v96, v150, v151
    v_max_u32 v96, v96, v97
    v_cmp_eq_u32 vcc, -1, v96
    s_add_u32 s80, s80, 1
    s_cmp_gt_u32 s80, 200000
    s_cbranch_scc1 L_B_okL6
    s_nop 0
    s_cbranch_vccnz L_B_rtL6_l
    s_branch L_B_okL6
L_B_rtL7:
    s_mov_b32 s80, 0
    s_add_u32 s31, s41, 7
    s_add_u32 s31, s31, s40
    s_and_b32 s31, s31, 31
    s_lshl_b32 s31, s31, 11
    s_add_u32 s31, s31, s42
L_B_rtL7_l:
    buffer_load_dwordx4 v[152:155], v1, s[12:15], s31 offen sc1
    buffer_load_dwordx4 v[156:159], v1, s[12:15], s31 offen offset:1024 sc1
    s_waitcnt vmcnt(0)
    v_max3_u32 v96, v152, v153, v154
    v_max3_u32 v97, v155, v156, v157
    v_max3_u32 v96, v96, v158, v159
    v_max_u32 v96, v96, v97
    v_cmp_eq_u32 vcc, -1, v96
    s_add_u32 s80, s80, 1
    s_cmp_gt_u32 s80, 200000
    s_cbranch_scc1 L_B_okL7
    s_nop 0
    s_cbranch_vccnz L_B_rtL7_l
    s_branch L_B_okL7
L_B_epi:
    s_waitcnt lgkmcnt(0)
    s_barrier
    s_lshl_b32 s56, s51, 13
    s_add_u32 s56, s56, 1179648
    s_add_u32 s57, s56, 4096
    buffer_load_dwordx4 v[128:131], v1, s[12:15], s56 offen offset:0 sc1
    buffer_load_dwordx4 v[132:135], v1, s[12:15], s56 offen offset:1024 sc1
    buffer_load_dwordx4 v[136:139], v1, s[12:15], s56 offen offset:2048 sc1
    buffer_load_dwordx4 v[140:143], v1, s[12:15], s56 offen offset:3072 sc1
    buffer_load_dwordx4 v[144:147], v1, s[12:15], s57 offen offset:0 sc1
    buffer_load_dwordx4 v[148:151], v1, s[12:15], s57 offen offset:1024 sc1
    buffer_load_dwordx4 v[152:155], v1, s[12:15], s57 offen offset:2048 sc1
    buffer_load_dwordx4 v[156:159], v1, s[12:15], s57 offen offset:3072 sc1
    v_and_b32 v106, 15, v8
    v_lshlrev_b32 v106, 2, v106
    s_waitcnt vmcnt(16)
    v_lshlrev_b32 v76, 16, v76
    v_add_u32 v107, 0, v106
    ds_bpermute_b32 v72, v107, v76
    v_add_u32 v107, 64, v106
    ds_bpermute_b32 v73, v107, v76
    v_add_u32 v107, 128, v106
    ds_bpermute_b32 v74, v107, v76
    v_add_u32 v107, 192, v106
    ds_bpermute_b32 v75, v107, v76
    s_waitcnt lgkmcnt(0)
    v_add_f32 v112, v112, v72
    v_add_f32 v113, v113, v72
    v_add_f32 v114, v114, v72
    v_add_f32 v115, v115, v72
    v_lshlrev_b32 v102, 16, v64
    v_and_b32 v103, 0xffff0000, v64
    v_lshlrev_b32 v104, 16, v65
    v_and_b32 v105, 0xffff0000, v65
    v_mul_f32 v112, v112, v102
    v_mul_f32 v113, v113, v103
    v_mul_f32 v114, v114, v104
    v_mul_f32 v115, v115, v105
    v_add_f32 v116, v116, v73
    v_add_f32 v117, v117, v73
    v_add_f32 v118, v118, v73
    v_add_f32 v119, v119, v73
    v_lshlrev_b32 v102, 16, v66
    v_and_b32 v103, 0xffff0000, v66
    v_lshlrev_b32 v104, 16, v67
    v_and_b32 v105, 0xffff0000, v67
    v_mul_f32 v116, v116, v102
    v_mul_f32 v117, v117, v103
    v_mul_f32 v118, v118, v104
    v_mul_f32 v119, v119, v105
    v_add_f32 v120, v120, v74
    v_add_f32 v121, v121, v74
    v_add_f32 v122, v122, v74
    v_add_f32 v123, v123, v74
    v_lshlrev_b32 v102, 16, v68
    v_and_b32 v103, 0xffff0000, v68
    v_lshlrev_b32 v104, 16, v69
    v_and_b32 v105, 0xffff0000, v69
    v_mul_f32 v120, v120, v102
    v_mul_f32 v121, v121, v103
    v_mul_f32 v122, v122, v104
    v_mul_f32 v123, v123, v105
    v_add_f32 v124, v124, v75
    v_add_f32 v125, v125, v75
    v_add_f32 v126, v126, v75
    v_add_f32 v127, v127, v75
    v_lshlrev_b32 v102, 16, v70
    v_and_b32 v103, 0xffff0000, v70
    v_lshlrev_b32 v104, 16, v71
    v_and_b32 v105, 0xffff0000, v71
    v_mul_f32 v124, v124, v102
    v_mul_f32 v125, v125, v103
    v_mul_f32 v126, v126, v104
    v_mul_f32 v127, v127, v105
    v_cvt_pk_bf16_f32 v76, v112, v113
    v_cvt_pk_bf16_f32 v77, v114, v115
    v_cvt_pk_bf16_f32 v78, v116, v117
    v_cvt_pk_bf16_f32 v79, v118, v119
    v_cvt_pk_bf16_f32 v80, v120, v121
    v_cvt_pk_bf16_f32 v81, v122, v123
    v_cvt_pk_bf16_f32 v82, v124, v125
    v_cvt_pk_bf16_f32 v83, v126, v127
    v_permlane16_swap_b32 v76, v78
    v_permlane16_swap_b32 v77, v79
    v_permlane16_swap_b32 v80, v82
    v_permlane16_swap_b32 v81, v83
    s_add_u32 s32, s55, 57344
    buffer_store_dwordx4 v[76:79], v1, s[12:15], s55 offen sc1
    buffer_store_dwordx4 v[80:83], v1, s[12:15], s32 offen sc1
    s_branch L_B_end
L_B_prod:
    s_and_b32 s40, s78, 7
    s_lshl_b32 s40, s40, 0
    s_and_b32 s31, s79, 3
    s_mul_i32 s31, s31, 0
    s_add_u32 s40, s40, s31
    s_and_b32 s40, s40, 31
    s_lshl_b32 s31, s78, 18
    s_add_u32 s16, s88, s31
    s_addc_u32 s17, s89, 0
    s_and_b32 s17, s17, 0xffff
    s_mov_b32 s18, 262144
    s_mov_b32 s19, 0x20000
    v_lshrrev_b32 v38, 3, v8
    v_and_b32 v39, 7, v8
    v_lshrrev_b32 v201, 1, v38
    v_xor_b32 v39, v39, v201
    v_lshlrev_b32 v39, 4, v39
    v_lshl_add_u32 v200, v38, 12, v39
    v_add_u32 v201, 32768, v200
    v_xor_b32 v201, 64, v201
    v_add_u32 v202, 65536, v200
    v_add_u32 v203, 98304, v200
    v_xor_b32 v203, 64, v203
    v_add_u32 v204, 131072, v200
    v_add_u32 v205, 163840, v200
    v_xor_b32 v205, 64, v205
    v_add_u32 v206, 196608, v200
    v_add_u32 v207, 229376, v200
    v_xor_b32 v207, 64, v207
    s_add_u32 s48, s40, 7
    s_mov_b32 s47, 57344
    s_and_b32 s48, s48, 31
    s_lshl_b32 s48, s48, 7
    v_lshrrev_b32 v38, 3, v8
    v_and_b32 v39, 7, v8
    v_lshrrev_b32 v46, 1, v38
    v_and_b32 v46, 1, v46
    v_lshlrev_b32 v46, 2, v46
    v_xor_b32 v39, v39, v46
    v_lshlrev_b32 v39, 4, v39
    v_lshl_add_u32 v46, v38, 10, v39
    s_mov_b32 s8, s94
    s_and_b32 s9, s95, 0xffff
    s_mov_b32 s10, 917504
    s_mov_b32 s11, 0x20000
    s_lshl_b32 s53, s79, 7
    s_mov_b32 s54, 65536
    s_barrier
    s_waitcnt vmcnt(32)
    s_barrier
    s_mov_b32 m0, s47
    s_nop 0
    buffer_load_dwordx4 v200, s[16:19], s48 offen lds
    s_add_u32 m0, s47, 1024
    s_nop 0
    buffer_load_dwordx4 v201, s[16:19], s48 offen lds
    s_add_u32 m0, s47, 2048
    s_nop 0
    buffer_load_dwordx4 v202, s[16:19], s48 offen lds
    s_add_u32 m0, s47, 3072
    s_nop 0
    buffer_load_dwordx4 v203, s[16:19], s48 offen lds
    s_add_u32 m0, s47, 4096
    s_nop 0
    buffer_load_dwordx4 v204, s[16:19], s48 offen lds
    s_add_u32 m0, s47, 5120
    s_nop 0
    buffer_load_dwordx4 v205, s[16:19], s48 offen lds
    s_add_u32 m0, s47, 6144
    s_nop 0
    buffer_load_dwordx4 v206, s[16:19], s48 offen lds
    s_add_u32 m0, s47, 7168
    s_nop 0
    buffer_load_dwordx4 v207, s[16:19], s48 offen lds
    s_add_u32 s47, s47, 8192
    s_and_b32 s47, s47, 65535
    s_add_u32 s48, s48, 128
    s_and_b32 s48, s48, 0xfff
    s_mov_b32 m0, s47
    s_nop 0
    buffer_load_dwordx4 v200, s[16:19], s48 offen lds
    s_add_u32 m0, s47, 1024
    s_nop 0
    buffer_load_dwordx4 v201, s[16:19], s48 offen lds
    s_add_u32 m0, s47, 2048
    s_nop 0
    buffer_load_dwordx4 v202, s[16:19], s48 offen lds
    s_add_u32 m0, s47, 3072
    s_nop 0
    buffer_load_dwordx4 v203, s[16:19], s48 offen lds
    s_add_u32 m0, s47, 4096
    s_nop 0
    buffer_load_dwordx4 v204, s[16:19], s48 offen lds
    s_add_u32 m0, s47, 5120
    s_nop 0
    buffer_load_dwordx4 v205, s[16:19], s48 offen lds
    s_add_u32 m0, s47, 6144
    s_nop 0
    buffer_load_dwordx4 v206, s[16:19], s48 offen lds
    s_add_u32 m0, s47, 7168
    s_nop 0
    buffer_load_dwordx4 v207, s[16:19], s48 offen lds
    s_add_u32 s47, s47, 8192
    s_and_b32 s47, s47, 65535
    s_add_u32 s48, s48, 128
    s_and_b32 s48, s48, 0xfff
    s_waitcnt vmcnt(32)
    s_barrier
    s_mov_b32 m0, s47
    s_nop 0
    buffer_load_dwordx4 v200, s[16:19], s48 offen lds
    s_add_u32 m0, s47, 1024
    s_nop 0
    buffer_load_dwordx4 v201, s[16:19], s48 offen lds
    s_add_u32 m0, s47, 2048
    s_nop 0
    buffer_load_dwordx4 v202, s[16:19], s48 offen lds
    s_add_u32 m0, s47, 3072
    s_nop 0
    buffer_load_dwordx4 v203, s[16:19], s48 offen lds
    s_add_u32 m0, s47, 4096
    s_nop 0
    buffer_load_dwordx4 v204, s[16:19], s48 offen lds
    s_add_u32 m0, s47, 5120
    s_nop 0
    buffer_load_dwordx4 v205, s[16:19], s48 offen lds
    s_add_u32 m0, s47, 6144
    s_nop 0
    buffer_load_dwordx4 v206, s[16:19], s48 offen lds
    s_add_u32 m0, s47, 7168
    s_nop 0
    buffer_load_dwordx4 v207, s[16:19], s48 offen lds
    s_add_u32 s47, s47, 8192
    s_and_b32 s47, s47, 65535
    s_add_u32 s48, s48, 128
    s_and_b32 s48, s48, 0xfff
    s_mov_b32 m0, s47
    s_nop 0
    buffer_load_dwordx4 v200, s[16:19], s48 offen lds
    s_add_u32 m0, s47, 1024
    s_nop 0
    buffer_load_dwordx4 v201, s[16:19], s48 offen lds
    s_add_u32 m0, s47, 2048
    s_nop 0
    buffer_load_dwordx4 v202, s[16:19], s48 offen lds
    s_add_u32 m0, s47, 3072
    s_nop 0
    buffer_load_dwordx4 v203, s[16:19], s48 offen lds
    s_add_u32 m0, s47, 4096
    s_nop 0
    buffer_load_dwordx4 v204, s[16:19], s48 offen lds
    s_add_u32 m0, s47, 5120
    s_nop 0
    buffer_load_dwordx4 v205, s[16:19], s48 offen lds
    s_add_u32 m0, s47, 6144
    s_nop 0
    buffer_load_dwordx4 v206, s[16:19], s48 offen lds
    s_add_u32 m0, s47, 7168
    s_nop 0
    buffer_load_dwordx4 v207, s[16:19], s48 offen lds
    s_add_u32 s47, s47, 8192
    s_and_b32 s47, s47, 65535
    s_add_u32 s48, s48, 128
    s_and_b32 s48, s48, 0xfff
    s_waitcnt vmcnt(32)
    s_lshr_b32 s31, s2, 2
    s_lshl_b32 s31, s31, 7
    s_and_b32 s32, s2, 3
    s_lshl_b32 s32, s32, 2
    s_add_u32 s31, s31, s32
    s_add_u32 s31, s31, 8192
    s_cmp_lg_u32 s24, 7
    s_cselect_b32 s31, 2130706432, s31
    v_mov_b32 v38, s29
    v_mov_b32 v39, 0
    s_mov_b64 s[60:61], exec
    s_mov_b64 exec, 1
    buffer_store_dword v38, v39, s[12:15], s31 offen sc1
    s_mov_b64 exec, s[60:61]
    s_mov_b32 s41, 4
L_B_pl:
    s_waitcnt vmcnt(32)
    s_barrier
    s_mov_b32 m0, s47
    s_nop 0
    buffer_load_dwordx4 v200, s[16:19], s48 offen lds
    s_add_u32 m0, s47, 1024
    s_nop 0
    buffer_load_dwordx4 v201, s[16:19], s48 offen lds
    s_add_u32 m0, s47, 2048
    s_nop 0
    buffer_load_dwordx4 v202, s[16:19], s48 offen lds
    s_add_u32 m0, s47, 3072
    s_nop 0
    buffer_load_dwordx4 v203, s[16:19], s48 offen lds
    s_add_u32 m0, s47, 4096
    s_nop 0
    buffer_load_dwordx4 v204, s[16:19], s48 offen lds
    s_add_u32 m0, s47, 5120
    s_nop 0
    buffer_load_dwordx4 v205, s[16:19], s48 offen lds
    s_add_u32 m0, s47, 6144
    s_nop 0
    buffer_load_dwordx4 v206, s[16:19], s48 offen lds
    s_add_u32 m0, s47, 7168
    s_nop 0
    buffer_load_dwordx4 v207, s[16:19], s48 offen lds
    s_add_u32 s47, s47, 8192
    s_and_b32 s47, s47, 65535
    s_add_u32 s48, s48, 128
    s_and_b32 s48, s48, 0xfff
    s_mov_b32 m0, s47
    s_nop 0
    buffer_load_dwordx4 v200, s[16:19], s48 offen lds
    s_add_u32 m0, s47, 1024
    s_nop 0
    buffer_load_dwordx4 v201, s[16:19], s48 offen lds
    s_add_u32 m0, s47, 2048
    s_nop 0
    buffer_load_dwordx4 v202, s[16:19], s48 offen lds
    s_add_u32 m0, s47, 3072
    s_nop 0
    buffer_load_dwordx4 v203, s[16:19], s48 offen lds
    s_add_u32 m0, s47, 4096
    s_nop 0
    buffer_load_dwordx4 v204, s[16:19], s48 offen lds
    s_add_u32 m0, s47, 5120
    s_nop 0
    buffer_load_dwordx4 v205, s[16:19], s48 offen lds
    s_add_u32 m0, s47, 6144
    s_nop 0
    buffer_load_dwordx4 v206, s[16:19], s48 offen lds
    s_add_u32 m0, s47, 7168
    s_nop 0
    buffer_load_dwordx4 v207, s[16:19], s48 offen lds
    s_add_u32 s47, s47, 8192
    s_and_b32 s47, s47, 65535
    s_add_u32 s48, s48, 128
    s_and_b32 s48, s48, 0xfff
    s_cmp_eq_u32 s41, 12
    s_cbranch_scc1 L_PJ1
    s_cmp_eq_u32 s41, 18
    s_cbranch_scc1 L_PJ2
    s_cmp_eq_u32 s41, 22
    s_cbranch_scc1 L_PJ3
L_PJe:
    s_add_u32 s41, s41, 2
    s_cmp_lt_u32 s41, 24
    s_cbranch_scc1 L_B_pl
    s_mov_b32 s8, s92
    s_and_b32 s9, s93, 0xffff
    s_mov_b32 s10, 524288
    s_mov_b32 s11, 0x20000
    s_lshl_b32 s53, s79, 7
    s_mov_b32 s54, 0
    s_waitcnt vmcnt(32)
    s_barrier
    s_mov_b32 m0, s47
    s_nop 0
    buffer_load_dwordx4 v200, s[16:19], s48 offen lds
    s_add_u32 m0, s47, 1024
    s_nop 0
    buffer_load_dwordx4 v201, s[16:19], s48 offen lds
    s_add_u32 m0, s47, 2048
    s_nop 0
    buffer_load_dwordx4 v202, s[16:19], s48 offen lds
    s_add_u32 m0, s47, 3072
    s_nop 0
    buffer_load_dwordx4 v203, s[16:19], s48 offen lds
    s_add_u32 m0, s47, 4096
    s_nop 0
    buffer_load_dwordx4 v204, s[16:19], s48 offen lds
    s_add_u32 m0, s47, 5120
    s_nop 0
    buffer_load_dwordx4 v205, s[16:19], s48 offen lds
    s_add_u32 m0, s47, 6144
    s_nop 0
    buffer_load_dwordx4 v206, s[16:19], s48 offen lds
    s_add_u32 m0, s47, 7168
    s_nop 0
    buffer_load_dwordx4 v207, s[16:19], s48 offen lds
    s_add_u32 s47, s47, 8192
    s_and_b32 s47, s47, 65535
    s_add_u32 s48, s48, 128
    s_and_b32 s48, s48, 0xfff
    s_mov_b32 m0, s54
    s_nop 0
    buffer_load_dwordx4 v46, s[8:11], s53 offen lds
    s_add_u32 m0, s54, 1024
    s_add_u32 s53, s53, 8192
    buffer_load_dwordx4 v46, s[8:11], s53 offen lds
    s_add_u32 m0, s54, 2048
    s_add_u32 s53, s53, 8192
    buffer_load_dwordx4 v46, s[8:11], s53 offen lds
    s_add_u32 m0, s54, 3072
    s_add_u32 s53, s53, 8192
    buffer_load_dwordx4 v46, s[8:11], s53 offen lds
    s_add_u32 m0, s54, 4096
    s_add_u32 s53, s53, 8192
    buffer_load_dwordx4 v46, s[8:11], s53 offen lds
    s_add_u32 m0, s54, 5120
    s_add_u32 s53, s53, 8192
    buffer_load_dwordx4 v46, s[8:11], s53 offen lds
    s_add_u32 m0, s54, 6144
    s_add_u32 s53, s53, 8192
    buffer_load_dwordx4 v46, s[8:11], s53 offen lds
    s_add_u32 m0, s54, 7168
    s_add_u32 s53, s53, 8192
    buffer_load_dwordx4 v46, s[8:11], s53 offen lds
    s_add_u32 s53, s53, 8192
    s_add_u32 s54, s54, 8192
    s_waitcnt vmcnt(24)
    s_barrier
    s_mov_b32 m0, s54
    s_nop 0
    buffer_load_dwordx4 v46, s[8:11], s53 offen lds
    s_add_u32 m0, s54, 1024
    s_add_u32 s53, s53, 8192
    buffer_load_dwordx4 v46, s[8:11], s53 offen lds
    s_add_u32 m0, s54, 2048
    s_add_u32 s53, s53, 8192
    buffer_load_dwordx4 v46, s[8:11], s53 offen lds
    s_add_u32 m0, s54, 3072
    s_add_u32 s53, s53, 8192
    buffer_load_dwordx4 v46, s[8:11], s53 offen lds
    s_add_u32 m0, s54, 4096
    s_add_u32 s53, s53, 8192
    buffer_load_dwordx4 v46, s[8:11], s53 offen lds
    s_add_u32 m0, s54, 5120
    s_add_u32 s53, s53, 8192
    buffer_load_dwordx4 v46, s[8:11], s53 offen lds
    s_add_u32 m0, s54, 6144
    s_add_u32 s53, s53, 8192
    buffer_load_dwordx4 v46, s[8:11], s53 offen lds
    s_add_u32 m0, s54, 7168
    s_add_u32 s53, s53, 8192
    buffer_load_dwordx4 v46, s[8:11], s53 offen lds
    s_add_u32 s53, s53, 8192
    s_add_u32 s54, s54, 8192
    s_mov_b32 m0, s54
    s_nop 0
    buffer_load_dwordx4 v46, s[8:11], s53 offen lds
    s_add_u32 m0, s54, 1024
    s_add_u32 s53, s53, 8192
    buffer_load_dwordx4 v46, s[8:11], s53 offen lds
    s_add_u32 m0, s54, 2048
    s_add_u32 s53, s53, 8192
    buffer_load_dwordx4 v46, s[8:11], s53 offen lds
    s_add_u32 m0, s54, 3072
    s_add_u32 s53, s53, 8192
    buffer_load_dwordx4 v46, s[8:11], s53 offen lds
    s_add_u32 m0, s54, 4096
    s_add_u32 s53, s53, 8192
    buffer_load_dwordx4 v46, s[8:11], s53 offen lds
    s_add_u32 m0, s54, 5120
    s_add_u32 s53, s53, 8192
    buffer_load_dwordx4 v46, s[8:11], s53 offen lds
    s_add_u32 m0, s54, 6144
    s_add_u32 s53, s53, 8192
    buffer_load_dwordx4 v46, s[8:11], s53 offen lds
    s_add_u32 m0, s54, 7168
    s_add_u32 s53, s53, 8192
    buffer_load_dwordx4 v46, s[8:11], s53 offen lds
    s_add_u32 s53, s53, 8192
    s_add_u32 s54, s54, 8192
    s_waitcnt vmcnt(24)
    s_barrier
    s_mov_b32 m0, s54
    s_nop 0
    buffer_load_dwordx4 v46, s[8:11], s53 offen lds
    s_add_u32 m0, s54, 1024
    s_add_u32 s53, s53, 8192
    buffer_load_dwordx4 v46, s[8:11], s53 offen lds
    s_add_u32 m0, s54, 2048
    s_add_u32 s53, s53, 8192
    buffer_load_dwordx4 v46, s[8:11], s53 offen lds
    s_add_u32 m0, s54, 3072
    s_add_u32 s53, s53, 8192
    buffer_load_dwordx4 v46, s[8:11], s53 offen lds
    s_add_u32 m0, s54, 4096
    s_add_u32 s53, s53, 8192
    buffer_load_dwordx4 v46, s[8:11], s53 offen lds
    s_add_u32 m0, s54, 5120
    s_add_u32 s53, s53, 8192
    buffer_load_dwordx4 v46, s[8:11], s53 offen lds
    s_add_u32 m0, s54, 6144
    s_add_u32 s53, s53, 8192
    buffer_load_dwordx4 v46, s[8:11], s53 offen lds
    s_add_u32 m0, s54, 7168
    s_add_u32 s53, s53, 8192
    buffer_load_dwordx4 v46, s[8:11], s53 offen lds
    s_add_u32 s53, s53, 8192
    s_add_u32 s54, s54, 8192
    s_mov_b32 m0, s54
    s_nop 0
    buffer_load_dwordx4 v46, s[8:11], s53 offen lds
    s_add_u32 m0, s54, 1024
    s_add_u32 s53, s53, 8192
    buffer_load_dwordx4 v46, s[8:11], s53 offen lds
    s_add_u32 m0, s54, 2048
    s_add_u32 s53, s53, 8192
    buffer_load_dwordx4 v46, s[8:11], s53 offen lds
    s_add_u32 m0, s54, 3072
    s_add_u32 s53, s53, 8192
    buffer_load_dwordx4 v46, s[8:11], s53 offen lds
    s_add_u32 m0, s54, 4096
    s_add_u32 s53, s53, 8192
    buffer_load_dwordx4 v46, s[8:11], s53 offen lds
    s_add_u32 m0, s54, 5120
    s_add_u32 s53, s53, 8192
    buffer_load_dwordx4 v46, s[8:11], s53 offen lds
    s_add_u32 m0, s54, 6144
    s_add_u32 s53, s53, 8192
    buffer_load_dwordx4 v46, s[8:11], s53 offen lds
    s_add_u32 m0, s54, 7168
    s_add_u32 s53, s53, 8192
    buffer_load_dwordx4 v46, s[8:11], s53 offen lds
    s_add_u32 s53, s53, 8192
    s_add_u32 s54, s54, 8192
    s_lshl_b32 s31, s52, 5
    s_lshl_b32 s32, s51, 3
    s_add_u32 s31, s31, s32
    s_add_u32 s31, s31, 0
    s_lshl_b32 s31, s31, 10
    s_add_u32 s31, s31, 10485760
    buffer_load_dwordx4 v[224:227], v1, s[12:15], s31 offen offset:0 sc1
    buffer_load_dwordx4 v[228:231], v1, s[12:15], s31 offen offset:1024 sc1
    buffer_load_dwordx4 v[232:235], v1, s[12:15], s31 offen offset:2048 sc1
    buffer_load_dwordx4 v[236:239], v1, s[12:15], s31 offen offset:3072 sc1
    s_lshl_b32 s31, s52, 5
    s_lshl_b32 s32, s51, 3
    s_add_u32 s31, s31, s32
    s_add_u32 s31, s31, 4
    s_lshl_b32 s31, s31, 10
    s_add_u32 s31, s31, 10485760
    buffer_load_dwordx4 v[240:243], v1, s[12:15], s31 offen offset:0 sc1
    buffer_load_dwordx4 v[244:247], v1, s[12:15], s31 offen offset:1024 sc1
    buffer_load_dwordx4 v[248:251], v1, s[12:15], s31 offen offset:2048 sc1
    buffer_load_dwordx4 v[252:255], v1, s[12:15], s31 offen offset:3072 sc1
    s_waitcnt vmcnt(32)
    s_barrier
    s_mov_b32 m0, s54
    s_nop 0
    buffer_load_dwordx4 v46, s[8:11], s53 offen lds
    s_add_u32 m0, s54, 1024
    s_add_u32 s53, s53, 8192
    buffer_load_dwordx4 v46, s[8:11], s53 offen lds
    s_add_u32 m0, s54, 2048
    s_add_u32 s53, s53, 8192
    buffer_load_dwordx4 v46, s[8:11], s53 offen lds
    s_add_u32 m0, s54, 3072
    s_add_u32 s53, s53, 8192
    buffer_load_dwordx4 v46, s[8:11], s53 offen lds
    s_add_u32 m0, s54, 4096
    s_add_u32 s53, s53, 8192
    buffer_load_dwordx4 v46, s[8:11], s53 offen lds
    s_add_u32 m0, s54, 5120
    s_add_u32 s53, s53, 8192
    buffer_load_dwordx4 v46, s[8:11], s53 offen lds
    s_add_u32 m0, s54, 6144
    s_add_u32 s53, s53, 8192
    buffer_load_dwordx4 v46, s[8:11], s53 offen lds
    s_add_u32 m0, s54, 7168
    s_add_u32 s53, s53, 8192
    buffer_load_dwordx4 v46, s[8:11], s53 offen lds
    s_add_u32 s53, s53, 8192
    s_add_u32 s54, s54, 8192
    s_mov_b32 m0, s54
    s_nop 0
    buffer_load_dwordx4 v46, s[8:11], s53 offen lds
    s_add_u32 m0, s54, 1024
    s_add_u32 s53, s53, 8192
    buffer_load_dwordx4 v46, s[8:11], s53 offen lds
    s_add_u32 m0, s54, 2048
    s_add_u32 s53, s53, 8192
    buffer_load_dwordx4 v46, s[8:11], s53 offen lds
    s_add_u32 m0, s54, 3072
    s_add_u32 s53, s53, 8192
    buffer_load_dwordx4 v46, s[8:11], s53 offen lds
    s_add_u32 m0, s54, 4096
    s_add_u32 s53, s53, 8192
    buffer_load_dwordx4 v46, s[8:11], s53 offen lds
    s_add_u32 m0, s54, 5120
    s_add_u32 s53, s53, 8192
    buffer_load_dwordx4 v46, s[8:11], s53 offen lds
    s_add_u32 m0, s54, 6144
    s_add_u32 s53, s53, 8192
    buffer_load_dwordx4 v46, s[8:11], s53 offen lds
    s_add_u32 m0, s54, 7168
    s_add_u32 s53, s53, 8192
    buffer_load_dwordx4 v46, s[8:11], s53 offen lds
    s_add_u32 s53, s53, 8192
    s_add_u32 s54, s54, 8192
    s_barrier
    s_mov_b32 m0, s54
    s_nop 0
    buffer_load_dwordx4 v46, s[8:11], s53 offen lds
    s_add_u32 m0, s54, 1024
    s_add_u32 s53, s53, 8192
    buffer_load_dwordx4 v46, s[8:11], s53 offen lds
    s_add_u32 m0, s54, 2048
    s_add_u32 s53, s53, 8192
    buffer_load_dwordx4 v46, s[8:11], s53 offen lds
    s_add_u32 m0, s54, 3072
    s_add_u32 s53, s53, 8192
    buffer_load_dwordx4 v46, s[8:11], s53 offen lds
    s_add_u32 m0, s54, 4096
    s_add_u32 s53, s53, 8192
    buffer_load_dwordx4 v46, s[8:11], s53 offen lds
    s_add_u32 m0, s54, 5120
    s_add_u32 s53, s53, 8192
    buffer_load_dwordx4 v46, s[8:11], s53 offen lds
    s_add_u32 m0, s54, 6144
    s_add_u32 s53, s53, 8192
    buffer_load_dwordx4 v46, s[8:11], s53 offen lds
    s_add_u32 m0, s54, 7168
    s_add_u32 s53, s53, 8192
    buffer_load_dwordx4 v46, s[8:11], s53 offen lds
    s_add_u32 s53, s53, 8192
    s_add_u32 s54, s54, 8192
    s_lshl_b32 s56, s51, 13
    s_add_u32 s56, s56, 1179648
    s_add_u32 s57, s56, 4096
    buffer_load_dwordx4 v[128:131], v1, s[12:15], s56 offen offset:0 sc1
    buffer_load_dwordx4 v[132:135], v1, s[12:15], s56 offen offset:1024 sc1
    buffer_load_dwordx4 v[136:139], v1, s[12:15], s56 offen offset:2048 sc1
    buffer_load_dwordx4 v[140:143], v1, s[12:15], s56 offen offset:3072 sc1
    buffer_load_dwordx4 v[144:147], v1, s[12:15], s57 offen offset:0 sc1
    buffer_load_dwordx4 v[148:151], v1, s[12:15], s57 offen offset:1024 sc1
    buffer_load_dwordx4 v[152:155], v1, s[12:15], s57 offen offset:2048 sc1
    buffer_load_dwordx4 v[156:159], v1, s[12:15], s57 offen offset:3072 sc1
    s_branch L_B_end
L_PJ1:
    v_lshlrev_b32 v38, 7, v8
    s_mov_b32 s31, 8192
    buffer_load_dwordx4 v[34:37], v38, s[12:15], s31 offen sc1
    s_branch L_PJe
L_PJ2:
    s_mov_b32 s80, 0
L_fcd_chk:
    v_xor_b32 v34, s29, v34
    v_xor_b32 v35, s29, v35
    v_xor_b32 v36, s29, v36
    v_xor_b32 v37, s29, v37
    v_or_b32 v34, v34, v35
    v_or3_b32 v34, v34, v36, v37
    v_cmp_ne_u32 vcc, 0, v34
    s_nop 3
    s_cbranch_vccz L_fcd_ok
    s_add_u32 s80, s80, 1
    s_cmp_gt_u32 s80, 200000
    s_cbranch_scc1 L_fcd_ok
    v_lshlrev_b32 v38, 7, v8
    s_mov_b32 s31, 8192
    buffer_load_dwordx4 v[34:37], v38, s[12:15], s31 offen sc1
    s_waitcnt vmcnt(0)
    s_branch L_fcd_chk
L_fcd_ok:
    s_cmp_ge_u32 s2, 32
    s_cbranch_scc1 L_PJe
    s_mul_i32 s31, s2, 1152
    s_add_u32 s31, s31, 524288
    buffer_load_dwordx4 v[128:131], v1, s[12:15], s31 offen sc1
    s_add_u32 s31, s31, 36864
    buffer_load_dwordx4 v[132:135], v1, s[12:15], s31 offen sc1
    s_add_u32 s31, s31, 36864
    buffer_load_dwordx4 v[136:139], v1, s[12:15], s31 offen sc1
    s_add_u32 s31, s31, 36864
    buffer_load_dwordx4 v[140:143], v1, s[12:15], s31 offen sc1
    s_add_u32 s31, s31, 36864
    buffer_load_dwordx4 v[144:147], v1, s[12:15], s31 offen sc1
    s_add_u32 s31, s31, 36864
    buffer_load_dwordx4 v[148:151], v1, s[12:15], s31 offen sc1
    s_add_u32 s31, s31, 36864
    buffer_load_dwordx4 v[152:155], v1, s[12:15], s31 offen sc1
    s_add_u32 s31, s31, 36864
    buffer_load_dwordx4 v[156:159], v1, s[12:15], s31 offen sc1
    s_add_u32 s31, s31, 36864
    buffer_load_dwordx4 v[160:163], v1, s[12:15], s31 offen sc1
    s_add_u32 s31, s31, 36864
    buffer_load_dwordx4 v[164:167], v1, s[12:15], s31 offen sc1
    s_add_u32 s31, s31, 36864
    buffer_load_dwordx4 v[168:171], v1, s[12:15], s31 offen sc1
    s_add_u32 s31, s31, 36864
    buffer_load_dwordx4 v[172:175], v1, s[12:15], s31 offen sc1
    s_add_u32 s31, s31, 36864
    buffer_load_dwordx4 v[176:179], v1, s[12:15], s31 offen sc1
    s_add_u32 s31, s31, 36864
    buffer_load_dwordx4 v[180:183], v1, s[12:15], s31 offen sc1
    s_add_u32 s31, s31, 36864
    buffer_load_dwordx4 v[184:187], v1, s[12:15], s31 offen sc1
    s_add_u32 s31, s31, 36864
    buffer_load_dwordx4 v[188:191], v1, s[12:15], s31 offen sc1
    v_lshrrev_b32 v96, 2, v8
    v_mul_u32_u24 v96, 36864, v96
    v_and_b32 v97, 3, v8
    v_lshl_add_u32 v96, v97, 4, v96
    s_mul_i32 s31, s2, 1152
    s_add_u32 s31, s31, 525312
    buffer_load_dwordx4 v[192:195], v96, s[12:15], s31 offen sc1
    s_branch L_PJe
L_PJ3:
    s_cmp_ge_u32 s2, 32
    s_cbranch_scc1 L_PJe
    s_waitcnt vmcnt(32)
    v_add_f32 v128, v128, v132
    v_add_f32 v129, v129, v133
    v_add_f32 v130, v130, v134
    v_add_f32 v131, v131, v135
    v_add_f32 v128, v128, v136
    v_add_f32 v129, v129, v137
    v_add_f32 v130, v130, v138
    v_add_f32 v131, v131, v139
    v_add_f32 v128, v128, v140
    v_add_f32 v129, v129, v141
    v_add_f32 v130, v130, v142
    v_add_f32 v131, v131, v143
    v_add_f32 v128, v128, v144
    v_add_f32 v129, v129, v145
    v_add_f32 v130, v130, v146
    v_add_f32 v131, v131, v147
    v_add_f32 v128, v128, v148
    v_add_f32 v129, v129, v149
    v_add_f32 v130, v130, v150
    v_add_f32 v131, v131, v151
    v_add_f32 v128, v128, v152
    v_add_f32 v129, v129, v153
    v_add_f32 v130, v130, v154
    v_add_f32 v131, v131, v155
    v_add_f32 v128, v128, v156
    v_add_f32 v129, v129, v157
    v_add_f32 v130, v130, v158
    v_add_f32 v131, v131, v159
    v_add_f32 v128, v128, v160
    v_add_f32 v129, v129, v161
    v_add_f32 v130, v130, v162
    v_add_f32 v131, v131, v163
    v_add_f32 v128, v128, v164
    v_add_f32 v129, v129, v165
    v_add_f32 v130, v130, v166
    v_add_f32 v131, v131, v167
    v_add_f32 v128, v128, v168
    v_add_f32 v129, v129, v169
    v_add_f32 v130, v130, v170
    v_add_f32 v131, v131, v171
    v_add_f32 v128, v128, v172
    v_add_f32 v129, v129, v173
    v_add_f32 v130, v130, v174
    v_add_f32 v131, v131, v175
    v_add_f32 v128, v128, v176
    v_add_f32 v129, v129, v177
    v_add_f32 v130, v130, v178
    v_add_f32 v131, v131, v179
    v_add_f32 v128, v128, v180
    v_add_f32 v129, v129, v181
    v_add_f32 v130, v130, v182
    v_add_f32 v131, v131, v183
    v_add_f32 v128, v128, v184
    v_add_f32 v129, v129, v185
    v_add_f32 v130, v130, v186
    v_add_f32 v131, v131, v187
    v_add_f32 v128, v128, v188
    v_add_f32 v129, v129, v189
    v_add_f32 v130, v130, v190
    v_add_f32 v131, v131, v191
    v_add_f32_dpp v192, v192, v192 row_ror:4 row_mask:0xf bank_mask:0xf
    v_add_f32_dpp v193, v193, v193 row_ror:4 row_mask:0xf bank_mask:0xf
    v_add_f32_dpp v194, v194, v194 row_ror:4 row_mask:0xf bank_mask:0xf
    v_add_f32_dpp v195, v195, v195 row_ror:4 row_mask:0xf bank_mask:0xf
    v_add_f32_dpp v192, v192, v192 row_ror:8 row_mask:0xf bank_mask:0xf
    v_add_f32_dpp v193, v193, v193 row_ror:8 row_mask:0xf bank_mask:0xf
    v_add_f32_dpp v194, v194, v194 row_ror:8 row_mask:0xf bank_mask:0xf
    v_add_f32_dpp v195, v195, v195 row_ror:8 row_mask:0xf bank_mask:0xf
    v_mov_b32 v96, v192
    v_mov_b32 v97, v193
    v_mov_b32 v98, v194
    v_mov_b32 v99, v195
    v_permlane16_swap_b32 v192, v96
    v_permlane16_swap_b32 v193, v97
    v_permlane16_swap_b32 v194, v98
    v_permlane16_swap_b32 v195, v99
    v_add_f32 v192, v192, v96
    v_add_f32 v193, v193, v97
    v_add_f32 v194, v194, v98
    v_add_f32 v195, v195, v99
    v_mov_b32 v96, v192
    v_mov_b32 v97, v193
    v_mov_b32 v98, v194
    v_mov_b32 v99, v195
    v_permlane32_swap_b32 v192, v96
    v_permlane32_swap_b32 v193, v97
    v_permlane32_swap_b32 v194, v98
    v_permlane32_swap_b32 v195, v99
    v_add_f32 v192, v192, v96
    v_add_f32 v193, v193, v97
    v_add_f32 v194, v194, v98
    v_add_f32 v195, v195, v99
    v_add_u32 v100, 155648, v1
    ds_write_b128 v100, v[128:131]
    v_and_b32 v101, 3, v8
    v_lshlrev_b32 v101, 4, v101
    v_add_u32 v101, 156672, v101
    ds_write_b128 v101, v[192:195]
    v_and_b32 v102, 15, v8
    v_lshrrev_b32 v103, 5, v8
    v_lshl_add_u32 v102, v103, 4, v102
    v_lshlrev_b32 v102, 2, v102
    v_add_u32 v102, 155648, v102
    v_lshlrev_b32 v103, 5, v103
    v_add_u32 v103, 156672, v103
    s_waitcnt lgkmcnt(0)
    ds_read_b32 v136, v102 offset:0
    ds_read_b32 v137, v102 offset:128
    ds_read_b32 v138, v102 offset:256
    ds_read_b32 v139, v102 offset:384
    ds_read_b32 v140, v102 offset:512
    ds_read_b32 v141, v102 offset:640
    ds_read_b32 v142, v102 offset:768
    ds_read_b32 v143, v102 offset:896
    ds_read_b128 v[144:147], v103
    ds_read_b128 v[148:151], v103 offset:16
    v_and_b32 v104, 16, v8
    v_cmp_eq_u32 vcc, 0, v104
    s_waitcnt lgkmcnt(0)
    s_nop 0
    v_cndmask_b32 v136, v144, v136, vcc
    v_cndmask_b32 v137, v145, v137, vcc
    v_cndmask_b32 v138, v146, v138, vcc
    v_cndmask_b32 v139, v147, v139, vcc
    v_cndmask_b32 v140, v148, v140, vcc
    v_cndmask_b32 v141, v149, v141, vcc
    v_cndmask_b32 v142, v150, v142, vcc
    v_cndmask_b32 v143, v151, v143, vcc
    v_cvt_pk_bf16_f32 v152, v136, v137
    v_cvt_pk_bf16_f32 v153, v138, v139
    v_cvt_pk_bf16_f32 v154, v140, v141
    v_cvt_pk_bf16_f32 v155, v142, v143
    s_lshl_b32 s31, s2, 10
    s_add_u32 s31, s31, 1179648
    buffer_store_dwordx4 v[152:155], v1, s[12:15], s31 offen sc1
    s_branch L_PJe
L_B_end:
    v_lshrrev_b32 v38, 3, v8
    v_and_b32 v39, 7, v8
    v_lshrrev_b32 v46, 1, v38
    v_and_b32 v46, 1, v46
    v_lshlrev_b32 v46, 2, v46
    v_xor_b32 v39, v39, v46
    v_lshlrev_b32 v39, 4, v39
    v_lshl_add_u32 v46, v38, 10, v39
    s_mov_b32 s16, s94
    s_and_b32 s17, s95, 0xffff
    s_mov_b32 s18, 917504
    s_mov_b32 s19, 0x20000
    v_lshrrev_b32 v32, 5, v8
    v_lshlrev_b32 v32, 9, v32
    v_sub_u32 v42, v4, v32
    s_lshl_b32 s31, s51, 14
    v_add_u32 v42, s31, v42
    s_mul_i32 s31, s51, 22528
    s_add_u32 s31, s31, 65536
    v_add_u32 v41, s31, v4
    s_mul_i32 s42, s52, 56
    s_mul_i32 s31, s51, 14
    s_add_u32 s42, s42, s31
    s_lshl_b32 s42, s42, 10
    s_add_u32 s42, s42, 12582912
    v_xor_b32 v36, 64, v42
    s_lshr_b32 s33, s24, 1
    s_and_b32 s34, s24, 1
    s_mul_i32 s31, s33, 224
    s_mul_i32 s32, s34, 88
    s_add_u32 s31, s31, s32
    s_lshl_b32 s31, s31, 10
    s_lshl_b32 s32, s79, 7
    s_add_u32 s31, s31, s32
    s_mul_i32 s33, s33, 22528
    s_mul_i32 s34, s34, 11264
    s_add_u32 s33, s33, s34
    s_add_u32 s33, s33, 65536
    s_mov_b32 s58, s33
    s_mov_b32 s59, s31
    s_cmp_eq_u32 s24, 7
    s_cbranch_scc1 L_C_w7
    s_waitcnt vmcnt(2)
    s_branch L_C_w0
L_C_w7:
    s_waitcnt vmcnt(0)
L_C_w0:
    s_barrier
    s_mov_b32 s80, 0
L_C_kvchk:
    v_max3_u32 v32, v128, v129, v130
    v_max3_u32 v32, v32, v131, v132
    v_max3_u32 v32, v32, v133, v134
    v_max3_u32 v32, v32, v135, v136
    v_max3_u32 v32, v32, v137, v138
    v_max3_u32 v32, v32, v139, v140
    v_max3_u32 v32, v32, v141, v142
    v_max3_u32 v32, v32, v143, v144
    v_max3_u32 v32, v32, v145, v146
    v_max3_u32 v32, v32, v147, v148
    v_max3_u32 v32, v32, v149, v150
    v_max3_u32 v32, v32, v151, v152
    v_max3_u32 v32, v32, v153, v154
    v_max3_u32 v32, v32, v155, v156
    v_max3_u32 v32, v32, v157, v158
    v_max_u32 v32, v32, v159
    v_cmp_eq_u32 vcc, -1, v32
    s_nop 3
    s_cbranch_vccz L_C_kvok
    s_add_u32 s80, s80, 1
    s_cmp_gt_u32 s80, 200000
    s_cbranch_scc1 L_C_kvok
    s_lshl_b32 s56, s51, 13
    s_add_u32 s56, s56, 1179648
    s_add_u32 s57, s56, 4096
    buffer_load_dwordx4 v[128:131], v1, s[12:15], s56 offen offset:0 sc1
    buffer_load_dwordx4 v[132:135], v1, s[12:15], s56 offen offset:1024 sc1
    buffer_load_dwordx4 v[136:139], v1, s[12:15], s56 offen offset:2048 sc1
    buffer_load_dwordx4 v[140:143], v1, s[12:15], s56 offen offset:3072 sc1
    buffer_load_dwordx4 v[144:147], v1, s[12:15], s57 offen offset:0 sc1
    buffer_load_dwordx4 v[148:151], v1, s[12:15], s57 offen offset:1024 sc1
    buffer_load_dwordx4 v[152:155], v1, s[12:15], s57 offen offset:2048 sc1
    buffer_load_dwordx4 v[156:159], v1, s[12:15], s57 offen offset:3072 sc1
    s_waitcnt vmcnt(0)
    s_branch L_C_kvchk
L_C_kvok:
    v_mfma_f32_32x32x16_bf16 v[96:111], v[128:131], v[224:227], 0
    ds_read_b64_tr_b16 v[16:17], v42 offset:0
    ds_read_b64_tr_b16 v[18:19], v42 offset:1024
    ds_read_b64_tr_b16 v[20:21], v36 offset:0
    ds_read_b64_tr_b16 v[22:23], v36 offset:1024
    v_mfma_f32_32x32x16_bf16 v[112:127], v[132:135], v[228:231], 0
    ds_read_b64_tr_b16 v[24:25], v42 offset:2048
    ds_read_b64_tr_b16 v[26:27], v42 offset:3072
    ds_read_b64_tr_b16 v[28:29], v36 offset:2048
    ds_read_b64_tr_b16 v[30:31], v36 offset:3072
    s_add_u32 m0, s58, 0
    s_add_u32 s31, s59, 0
    buffer_load_dwordx4 v46, s[16:19], s31 offen lds
    s_add_u32 m0, s58, 1024
    s_add_u32 s31, s59, 8192
    buffer_load_dwordx4 v46, s[16:19], s31 offen lds
    v_add_f32 v32, s81, v104
    v_rcp_f32 v32, v32
    s_nop 0
    v_mul_f32 v96, v96, v32
    v_mul_f32 v97, v97, v32
    v_mul_f32 v98, v98, v32
    v_mul_f32 v99, v99, v32
    v_mul_f32 v100, v100, v32
    v_mul_f32 v101, v101, v32
    v_mul_f32 v102, v102, v32
    v_mul_f32 v103, v103, v32
    v_cvt_pk_bf16_f32 v216, v96, v97
    v_cvt_pk_bf16_f32 v217, v98, v99
    v_cvt_pk_bf16_f32 v218, v100, v101
    v_cvt_pk_bf16_f32 v219, v102, v103
    s_waitcnt lgkmcnt(4)
    s_nop 0
    v_mfma_f32_32x32x16_bf16 v[48:63], v[16:19], v[216:219], 0
    v_mfma_f32_32x32x16_bf16 v[64:79], v[20:23], v[216:219], 0
    v_mfma_f32_32x32x16_bf16 v[96:111], v[136:139], v[232:235], 0
    ds_read_b64_tr_b16 v[16:17], v42 offset:4096
    ds_read_b64_tr_b16 v[18:19], v42 offset:5120
    ds_read_b64_tr_b16 v[20:21], v36 offset:4096
    ds_read_b64_tr_b16 v[22:23], v36 offset:5120
    s_add_u32 m0, s58, 2048
    s_add_u32 s31, s59, 16384
    buffer_load_dwordx4 v46, s[16:19], s31 offen lds
    s_add_u32 m0, s58, 3072
    s_add_u32 s31, s59, 24576
    buffer_load_dwordx4 v46, s[16:19], s31 offen lds
    v_add_f32 v32, s81, v120
    v_rcp_f32 v32, v32
    s_nop 0
    v_mul_f32 v112, v112, v32
    v_mul_f32 v113, v113, v32
    v_mul_f32 v114, v114, v32
    v_mul_f32 v115, v115, v32
    v_mul_f32 v116, v116, v32
    v_mul_f32 v117, v117, v32
    v_mul_f32 v118, v118, v32
    v_mul_f32 v119, v119, v32
    v_cvt_pk_bf16_f32 v220, v112, v113
    v_cvt_pk_bf16_f32 v221, v114, v115
    v_cvt_pk_bf16_f32 v222, v116, v117
    v_cvt_pk_bf16_f32 v223, v118, v119
    s_waitcnt lgkmcnt(4)
    s_nop 0
    v_mfma_f32_32x32x16_bf16 v[48:63], v[24:27], v[220:223], v[48:63]
    v_mfma_f32_32x32x16_bf16 v[64:79], v[28:31], v[220:223], v[64:79]
    v_mfma_f32_32x32x16_bf16 v[112:127], v[140:143], v[236:239], 0
    ds_read_b64_tr_b16 v[24:25], v42 offset:6144
    ds_read_b64_tr_b16 v[26:27], v42 offset:7168
    ds_read_b64_tr_b16 v[28:29], v36 offset:6144
    ds_read_b64_tr_b16 v[30:31], v36 offset:7168
    s_add_u32 m0, s58, 4096
    s_add_u32 s31, s59, 32768
    buffer_load_dwordx4 v46, s[16:19], s31 offen lds
    s_add_u32 m0, s58, 5120
    s_add_u32 s31, s59, 40960
    buffer_load_dwordx4 v46, s[16:19], s31 offen lds
    v_add_f32 v32, s81, v104
    v_rcp_f32 v32, v32
    s_nop 0
    v_mul_f32 v96, v96, v32
    v_mul_f32 v97, v97, v32
    v_mul_f32 v98, v98, v32
    v_mul_f32 v99, v99, v32
    v_mul_f32 v100, v100, v32
    v_mul_f32 v101, v101, v32
    v_mul_f32 v102, v102, v32
    v_mul_f32 v103, v103, v32
    v_cvt_pk_bf16_f32 v216, v96, v97
    v_cvt_pk_bf16_f32 v217, v98, v99
    v_cvt_pk_bf16_f32 v218, v100, v101
    v_cvt_pk_bf16_f32 v219, v102, v103
    s_waitcnt lgkmcnt(4)
    s_nop 0
    v_mfma_f32_32x32x16_bf16 v[48:63], v[16:19], v[216:219], v[48:63]
    v_mfma_f32_32x32x16_bf16 v[64:79], v[20:23], v[216:219], v[64:79]
    v_mfma_f32_32x32x16_bf16 v[96:111], v[144:147], v[240:243], 0
    ds_read_b64_tr_b16 v[16:17], v42 offset:8192
    ds_read_b64_tr_b16 v[18:19], v42 offset:9216
    ds_read_b64_tr_b16 v[20:21], v36 offset:8192
    ds_read_b64_tr_b16 v[22:23], v36 offset:9216
    s_add_u32 m0, s58, 6144
    s_add_u32 s31, s59, 49152
    buffer_load_dwordx4 v46, s[16:19], s31 offen lds
    s_add_u32 m0, s58, 7168
    s_add_u32 s31, s59, 57344
    buffer_load_dwordx4 v46, s[16:19], s31 offen lds
    v_add_f32 v32, s81, v120
    v_rcp_f32 v32, v32
    s_nop 0
    v_mul_f32 v112, v112, v32
    v_mul_f32 v113, v113, v32
    v_mul_f32 v114, v114, v32
    v_mul_f32 v115, v115, v32
    v_mul_f32 v116, v116, v32
    v_mul_f32 v117, v117, v32
    v_mul_f32 v118, v118, v32
    v_mul_f32 v119, v119, v32
    v_cvt_pk_bf16_f32 v220, v112, v113
    v_cvt_pk_bf16_f32 v221, v114, v115
    v_cvt_pk_bf16_f32 v222, v116, v117
    v_cvt_pk_bf16_f32 v223, v118, v119
    s_waitcnt lgkmcnt(4)
    s_nop 0
    v_mfma_f32_32x32x16_bf16 v[48:63], v[24:27], v[220:223], v[48:63]
    v_mfma_f32_32x32x16_bf16 v[64:79], v[28:31], v[220:223], v[64:79]
    v_mfma_f32_32x32x16_bf16 v[112:127], v[148:151], v[244:247], 0
    ds_read_b64_tr_b16 v[24:25], v42 offset:10240
    ds_read_b64_tr_b16 v[26:27], v42 offset:11264
    ds_read_b64_tr_b16 v[28:29], v36 offset:10240
    ds_read_b64_tr_b16 v[30:31], v36 offset:11264
    s_add_u32 m0, s58, 8192
    s_add_u32 s31, s59, 65536
    buffer_load_dwordx4 v46, s[16:19], s31 offen lds
    s_add_u32 m0, s58, 9216
    s_add_u32 s31, s59, 73728
    buffer_load_dwordx4 v46, s[16:19], s31 offen lds
    v_add_f32 v32, s81, v104
    v_rcp_f32 v32, v32
    s_nop 0
    v_mul_f32 v96, v96, v32
    v_mul_f32 v97, v97, v32
    v_mul_f32 v98, v98, v32
    v_mul_f32 v99, v99, v32
    v_mul_f32 v100, v100, v32
    v_mul_f32 v101, v101, v32
    v_mul_f32 v102, v102, v32
    v_mul_f32 v103, v103, v32
    v_cvt_pk_bf16_f32 v216, v96, v97
    v_cvt_pk_bf16_f32 v217, v98, v99
    v_cvt_pk_bf16_f32 v218, v100, v101
    v_cvt_pk_bf16_f32 v219, v102, v103
    s_waitcnt lgkmcnt(4)
    s_nop 0
    v_mfma_f32_32x32x16_bf16 v[48:63], v[16:19], v[216:219], v[48:63]
    v_mfma_f32_32x32x16_bf16 v[64:79], v[20:23], v[216:219], v[64:79]
    v_mfma_f32_32x32x16_bf16 v[96:111], v[152:155], v[248:251], 0
    ds_read_b64_tr_b16 v[16:17], v42 offset:12288
    ds_read_b64_tr_b16 v[18:19], v42 offset:13312
    ds_read_b64_tr_b16 v[20:21], v36 offset:12288
    ds_read_b64_tr_b16 v[22:23], v36 offset:13312
    s_add_u32 m0, s58, 10240
    s_add_u32 s31, s59, 81920
    buffer_load_dwordx4 v46, s[16:19], s31 offen lds
    s_add_u32 s31, s42, 0
    buffer_load_dwordx4 v[160:163], v1, s[12:15], s31 offen offset:0 sc1
    buffer_load_dwordx4 v[164:167], v1, s[12:15], s31 offen offset:1024 sc1
    buffer_load_dwordx4 v[168:171], v1, s[12:15], s31 offen offset:2048 sc1
    buffer_load_dwordx4 v[172:175], v1, s[12:15], s31 offen offset:3072 sc1
    s_add_u32 s31, s42, 4096
    buffer_load_dwordx4 v[176:179], v1, s[12:15], s31 offen offset:0 sc1
    buffer_load_dwordx4 v[180:183], v1, s[12:15], s31 offen offset:1024 sc1
    buffer_load_dwordx4 v[184:187], v1, s[12:15], s31 offen offset:2048 sc1
    buffer_load_dwordx4 v[188:191], v1, s[12:15], s31 offen offset:3072 sc1
    s_add_u32 s31, s42, 8192
    buffer_load_dwordx4 v[192:195], v1, s[12:15], s31 offen offset:0 sc1
    buffer_load_dwordx4 v[196:199], v1, s[12:15], s31 offen offset:1024 sc1
    buffer_load_dwordx4 v[200:203], v1, s[12:15], s31 offen offset:2048 sc1
    buffer_load_dwordx4 v[204:207], v1, s[12:15], s31 offen offset:3072 sc1
    s_add_u32 s31, s42, 12288
    buffer_load_dwordx4 v[208:211], v1, s[12:15], s31 offen offset:0 sc1
    buffer_load_dwordx4 v[212:215], v1, s[12:15], s31 offen offset:1024 sc1
    v_add_f32 v32, s81, v120
    v_rcp_f32 v32, v32
    s_nop 0
    v_mul_f32 v112, v112, v32
    v_mul_f32 v113, v113, v32
    v_mul_f32 v114, v114, v32
    v_mul_f32 v115, v115, v32
    v_mul_f32 v116, v116, v32
    v_mul_f32 v117, v117, v32
    v_mul_f32 v118, v118, v32
    v_mul_f32 v119, v119, v32
    v_cvt_pk_bf16_f32 v220, v112, v113
    v_cvt_pk_bf16_f32 v221, v114, v115
    v_cvt_pk_bf16_f32 v222, v116, v117
    v_cvt_pk_bf16_f32 v223, v118, v119
    s_waitcnt lgkmcnt(4)
    s_nop 0
    v_mfma_f32_32x32x16_bf16 v[48:63], v[24:27], v[220:223], v[48:63]
    v_mfma_f32_32x32x16_bf16 v[64:79], v[28:31], v[220:223], v[64:79]
    v_mfma_f32_32x32x16_bf16 v[112:127], v[156:159], v[252:255], 0
    ds_read_b64_tr_b16 v[24:25], v42 offset:14336
    ds_read_b64_tr_b16 v[26:27], v42 offset:15360
    ds_read_b64_tr_b16 v[28:29], v36 offset:14336
    ds_read_b64_tr_b16 v[30:31], v36 offset:15360
    v_add_f32 v32, s81, v104
    v_rcp_f32 v32, v32
    s_nop 0
    v_mul_f32 v96, v96, v32
    v_mul_f32 v97, v97, v32
    v_mul_f32 v98, v98, v32
    v_mul_f32 v99, v99, v32
    v_mul_f32 v100, v100, v32
    v_mul_f32 v101, v101, v32
    v_mul_f32 v102, v102, v32
    v_mul_f32 v103, v103, v32
    v_cvt_pk_bf16_f32 v216, v96, v97
    v_cvt_pk_bf16_f32 v217, v98, v99
    v_cvt_pk_bf16_f32 v218, v100, v101
    v_cvt_pk_bf16_f32 v219, v102, v103
    s_waitcnt lgkmcnt(4)
    s_nop 0
    v_mfma_f32_32x32x16_bf16 v[48:63], v[16:19], v[216:219], v[48:63]
    v_mfma_f32_32x32x16_bf16 v[64:79], v[20:23], v[216:219], v[64:79]
    v_add_f32 v32, s81, v120
    v_rcp_f32 v32, v32
    s_nop 0
    v_mul_f32 v112, v112, v32
    v_mul_f32 v113, v113, v32
    v_mul_f32 v114, v114, v32
    v_mul_f32 v115, v115, v32
    v_mul_f32 v116, v116, v32
    v_mul_f32 v117, v117, v32
    v_mul_f32 v118, v118, v32
    v_mul_f32 v119, v119, v32
    v_cvt_pk_bf16_f32 v220, v112, v113
    v_cvt_pk_bf16_f32 v221, v114, v115
    v_cvt_pk_bf16_f32 v222, v116, v117
    v_cvt_pk_bf16_f32 v223, v118, v119
    s_waitcnt lgkmcnt(0)
    s_nop 0
    v_mfma_f32_32x32x16_bf16 v[48:63], v[24:27], v[220:223], v[48:63]
    v_mfma_f32_32x32x16_bf16 v[64:79], v[28:31], v[220:223], v[64:79]
    s_waitcnt vmcnt(14)
    s_barrier
    s_lshr_b32 s33, s24, 1
    s_and_b32 s34, s24, 1
    s_mul_i32 s31, s33, 224
    s_mul_i32 s32, s34, 24
    s_add_u32 s31, s31, s32
    s_add_u32 s31, s31, 176
    s_lshl_b32 s31, s31, 10
    s_lshl_b32 s32, s79, 7
    s_add_u32 s31, s31, s32
    s_mul_i32 s33, s33, 6144
    s_mul_i32 s34, s34, 3072
    s_add_u32 s33, s33, s34
    s_add_u32 m0, s33, 0
    s_nop 0
    buffer_load_dwordx4 v46, s[16:19], s31 offen lds
    s_add_u32 m0, s33, 1024
    s_add_u32 s31, s31, 8192
    buffer_load_dwordx4 v46, s[16:19], s31 offen lds
    s_add_u32 m0, s33, 2048
    s_add_u32 s31, s31, 8192
    buffer_load_dwordx4 v46, s[16:19], s31 offen lds
    s_lshl_b32 s31, s50, 15
    s_lshl_b32 s32, s51, 11
    s_add_u32 s31, s31, s32
    s_add_u32 s31, s31, 32768
    v_and_b32 v33, 31, v8
    v_lshlrev_b32 v33, 10, v33
    v_lshrrev_b32 v34, 5, v8
    v_lshl_add_u32 v43, v34, 3, v33
    s_lshl_b32 s31, s52, 15
    s_lshl_b32 s32, s79, 7
    s_add_u32 s31, s31, s32
    s_lshl_b32 s32, s51, 5
    s_add_u32 s56, s31, s32
    buffer_load_dwordx2 v[220:221], v43, s[4:7], s56 offen
    buffer_load_dwordx2 v[222:223], v43, s[4:7], s56 offen offset:16
    s_waitcnt vmcnt(5)
    s_mov_b32 s80, 0
L_C_uchk:
    v_max3_u32 v32, v160, v161, v162
    v_max3_u32 v32, v32, v163, v164
    v_max3_u32 v32, v32, v165, v166
    v_max3_u32 v32, v32, v167, v168
    v_max3_u32 v32, v32, v169, v170
    v_max3_u32 v32, v32, v171, v172
    v_max3_u32 v32, v32, v173, v174
    v_max3_u32 v32, v32, v175, v176
    v_max3_u32 v32, v32, v177, v178
    v_max3_u32 v32, v32, v179, v180
    v_max3_u32 v32, v32, v181, v182
    v_max3_u32 v32, v32, v183, v184
    v_max3_u32 v32, v32, v185, v186
    v_max3_u32 v32, v32, v187, v188
    v_max3_u32 v32, v32, v189, v190
    v_max3_u32 v32, v32, v191, v192
    v_max3_u32 v32, v32, v193, v194
    v_max3_u32 v32, v32, v195, v196
    v_max3_u32 v32, v32, v197, v198
    v_max3_u32 v32, v32, v199, v200
    v_max3_u32 v32, v32, v201, v202
    v_max3_u32 v32, v32, v203, v204
    v_max3_u32 v32, v32, v205, v206
    v_max3_u32 v32, v32, v207, v208
    v_max3_u32 v32, v32, v209, v210
    v_max3_u32 v32, v32, v211, v212
    v_max3_u32 v32, v32, v213, v214
    v_max_u32 v32, v32, v215
    v_cmp_eq_u32 vcc, -1, v32
    s_nop 3
    s_cbranch_vccz L_C_uok
    s_add_u32 s80, s80, 1
    s_cmp_gt_u32 s80, 200000
    s_cbranch_scc1 L_C_uok
    s_add_u32 s31, s42, 0
    buffer_load_dwordx4 v[160:163], v1, s[12:15], s31 offen offset:0 sc1
    buffer_load_dwordx4 v[164:167], v1, s[12:15], s31 offen offset:1024 sc1
    buffer_load_dwordx4 v[168:171], v1, s[12:15], s31 offen offset:2048 sc1
    buffer_load_dwordx4 v[172:175], v1, s[12:15], s31 offen offset:3072 sc1
    s_add_u32 s31, s42, 4096
    buffer_load_dwordx4 v[176:179], v1, s[12:15], s31 offen offset:0 sc1
    buffer_load_dwordx4 v[180:183], v1, s[12:15], s31 offen offset:1024 sc1
    buffer_load_dwordx4 v[184:187], v1, s[12:15], s31 offen offset:2048 sc1
    buffer_load_dwordx4 v[188:191], v1, s[12:15], s31 offen offset:3072 sc1
    s_add_u32 s31, s42, 8192
    buffer_load_dwordx4 v[192:195], v1, s[12:15], s31 offen offset:0 sc1
    buffer_load_dwordx4 v[196:199], v1, s[12:15], s31 offen offset:1024 sc1
    buffer_load_dwordx4 v[200:203], v1, s[12:15], s31 offen offset:2048 sc1
    buffer_load_dwordx4 v[204:207], v1, s[12:15], s31 offen offset:3072 sc1
    s_add_u32 s31, s42, 12288
    buffer_load_dwordx4 v[208:211], v1, s[12:15], s31 offen offset:0 sc1
    buffer_load_dwordx4 v[212:215], v1, s[12:15], s31 offen offset:1024 sc1
    s_waitcnt vmcnt(0)
    s_branch L_C_uchk
L_C_uok:
    v_xor_b32 v36, 64, v41
    s_mul_i32 s31, s51, 6144
    v_add_u32 v37, s31, v4
    v_xor_b32 v38, 64, v37
    ds_read_b64_tr_b16 v[16:17], v41 offset:0
    ds_read_b64_tr_b16 v[18:19], v41 offset:512
    ds_read_b64_tr_b16 v[20:21], v36 offset:0
    ds_read_b64_tr_b16 v[22:23], v36 offset:512
    ds_read_b64_tr_b16 v[24:25], v41 offset:2048
    ds_read_b64_tr_b16 v[26:27], v41 offset:2560
    ds_read_b64_tr_b16 v[28:29], v36 offset:2048
    ds_read_b64_tr_b16 v[30:31], v36 offset:2560
    ds_read_b64_tr_b16 v[128:129], v41 offset:4096
    ds_read_b64_tr_b16 v[130:131], v41 offset:4608
    ds_read_b64_tr_b16 v[132:133], v36 offset:4096
    ds_read_b64_tr_b16 v[134:135], v36 offset:4608
    s_waitcnt lgkmcnt(8)
    v_mfma_f32_32x32x16_bf16 v[80:95], v[16:19], v[160:163], 0
    v_mfma_f32_32x32x16_bf16 v[96:111], v[20:23], v[160:163], 0
    ds_read_b64_tr_b16 v[136:137], v41 offset:6144
    ds_read_b64_tr_b16 v[138:139], v41 offset:6656
    ds_read_b64_tr_b16 v[140:141], v36 offset:6144
    ds_read_b64_tr_b16 v[142:143], v36 offset:6656
    s_waitcnt lgkmcnt(8)
    v_mfma_f32_32x32x16_bf16 v[80:95], v[24:27], v[164:167], v[80:95]
    v_mfma_f32_32x32x16_bf16 v[96:111], v[28:31], v[164:167], v[96:111]
    ds_read_b64_tr_b16 v[16:17], v41 offset:8192
    ds_read_b64_tr_b16 v[18:19], v41 offset:8704
    ds_read_b64_tr_b16 v[20:21], v36 offset:8192
    ds_read_b64_tr_b16 v[22:23], v36 offset:8704
    s_waitcnt lgkmcnt(8)
    v_mfma_f32_32x32x16_bf16 v[80:95], v[128:131], v[168:171], v[80:95]
    v_mfma_f32_32x32x16_bf16 v[96:111], v[132:135], v[168:171], v[96:111]
    ds_read_b64_tr_b16 v[24:25], v41 offset:10240
    ds_read_b64_tr_b16 v[26:27], v41 offset:10752
    ds_read_b64_tr_b16 v[28:29], v36 offset:10240
    ds_read_b64_tr_b16 v[30:31], v36 offset:10752
    s_waitcnt lgkmcnt(8)
    v_mfma_f32_32x32x16_bf16 v[80:95], v[136:139], v[172:175], v[80:95]
    v_mfma_f32_32x32x16_bf16 v[96:111], v[140:143], v[172:175], v[96:111]
    ds_read_b64_tr_b16 v[128:129], v41 offset:12288
    ds_read_b64_tr_b16 v[130:131], v41 offset:12800
    ds_read_b64_tr_b16 v[132:133], v36 offset:12288
    ds_read_b64_tr_b16 v[134:135], v36 offset:12800
    s_waitcnt lgkmcnt(8)
    v_mfma_f32_32x32x16_bf16 v[80:95], v[16:19], v[176:179], v[80:95]
    v_mfma_f32_32x32x16_bf16 v[96:111], v[20:23], v[176:179], v[96:111]
    ds_read_b64_tr_b16 v[136:137], v41 offset:14336
    ds_read_b64_tr_b16 v[138:139], v41 offset:14848
    ds_read_b64_tr_b16 v[140:141], v36 offset:14336
    ds_read_b64_tr_b16 v[142:143], v36 offset:14848
    s_waitcnt lgkmcnt(8)
    v_mfma_f32_32x32x16_bf16 v[80:95], v[24:27], v[180:183], v[80:95]
    v_mfma_f32_32x32x16_bf16 v[96:111], v[28:31], v[180:183], v[96:111]
    ds_read_b64_tr_b16 v[16:17], v41 offset:16384
    ds_read_b64_tr_b16 v[18:19], v41 offset:16896
    ds_read_b64_tr_b16 v[20:21], v36 offset:16384
    ds_read_b64_tr_b16 v[22:23], v36 offset:16896
    s_waitcnt lgkmcnt(8)
    v_mfma_f32_32x32x16_bf16 v[80:95], v[128:131], v[184:187], v[80:95]
    v_mfma_f32_32x32x16_bf16 v[96:111], v[132:135], v[184:187], v[96:111]
    ds_read_b64_tr_b16 v[24:25], v41 offset:18432
    ds_read_b64_tr_b16 v[26:27], v41 offset:18944
    ds_read_b64_tr_b16 v[28:29], v36 offset:18432
    ds_read_b64_tr_b16 v[30:31], v36 offset:18944
    s_waitcnt lgkmcnt(8)
    v_mfma_f32_32x32x16_bf16 v[80:95], v[136:139], v[188:191], v[80:95]
    v_mfma_f32_32x32x16_bf16 v[96:111], v[140:143], v[188:191], v[96:111]
    ds_read_b64_tr_b16 v[128:129], v41 offset:20480
    ds_read_b64_tr_b16 v[130:131], v41 offset:20992
    ds_read_b64_tr_b16 v[132:133], v36 offset:20480
    ds_read_b64_tr_b16 v[134:135], v36 offset:20992
    s_waitcnt lgkmcnt(8)
    v_mfma_f32_32x32x16_bf16 v[80:95], v[16:19], v[192:195], v[80:95]
    v_mfma_f32_32x32x16_bf16 v[96:111], v[20:23], v[192:195], v[96:111]
    s_waitcnt vmcnt(0)
    s_barrier
    ds_read_b64_tr_b16 v[136:137], v37 offset:0
    ds_read_b64_tr_b16 v[138:139], v37 offset:512
    ds_read_b64_tr_b16 v[140:141], v38 offset:0
    ds_read_b64_tr_b16 v[142:143], v38 offset:512
    s_waitcnt lgkmcnt(8)
    v_mfma_f32_32x32x16_bf16 v[80:95], v[24:27], v[196:199], v[80:95]
    v_mfma_f32_32x32x16_bf16 v[96:111], v[28:31], v[196:199], v[96:111]
    ds_read_b64_tr_b16 v[16:17], v37 offset:2048
    ds_read_b64_tr_b16 v[18:19], v37 offset:2560
    ds_read_b64_tr_b16 v[20:21], v38 offset:2048
    ds_read_b64_tr_b16 v[22:23], v38 offset:2560
    s_waitcnt lgkmcnt(8)
    v_mfma_f32_32x32x16_bf16 v[80:95], v[128:131], v[200:203], v[80:95]
    v_mfma_f32_32x32x16_bf16 v[96:111], v[132:135], v[200:203], v[96:111]
    ds_read_b64_tr_b16 v[24:25], v37 offset:4096
    ds_read_b64_tr_b16 v[26:27], v37 offset:4608
    ds_read_b64_tr_b16 v[28:29], v38 offset:4096
    ds_read_b64_tr_b16 v[30:31], v38 offset:4608
    s_waitcnt lgkmcnt(8)
    v_mfma_f32_32x32x16_bf16 v[80:95], v[136:139], v[204:207], v[80:95]
    v_mfma_f32_32x32x16_bf16 v[96:111], v[140:143], v[204:207], v[96:111]
    s_waitcnt lgkmcnt(4)
    v_mfma_f32_32x32x16_bf16 v[80:95], v[16:19], v[208:211], v[80:95]
    v_mfma_f32_32x32x16_bf16 v[96:111], v[20:23], v[208:211], v[96:111]
    s_waitcnt lgkmcnt(0)
    v_mfma_f32_32x32x16_bf16 v[80:95], v[24:27], v[212:215], v[80:95]
    v_mfma_f32_32x32x16_bf16 v[96:111], v[28:31], v[212:215], v[96:111]
    s_barrier
    s_lshl_b32 s31, s50, 16
    s_lshl_b32 s32, s51, 12
    s_add_u32 s31, s31, s32
    v_add_u32 v32, s31, v1
L_C_q0:
    s_cmp_eq_u32 s51, 0
    s_cbranch_scc0 L_C_q1
    ds_write_b128 v32, v[56:59] offset:16384
    ds_write_b128 v32, v[60:63] offset:17408
    s_nop 1
    ds_write_b128 v32, v[88:91] offset:18432
    ds_write_b128 v32, v[92:95] offset:19456
    ds_write_b128 v32, v[64:67] offset:32768
    ds_write_b128 v32, v[68:71] offset:33792
    ds_write_b128 v32, v[96:99] offset:34816
    ds_write_b128 v32, v[100:103] offset:35840
    ds_write_b128 v32, v[72:75] offset:49152
    ds_write_b128 v32, v[76:79] offset:50176
    ds_write_b128 v32, v[104:107] offset:51200
    ds_write_b128 v32, v[108:111] offset:52224
    v_mov_b32 v112, v48
    v_mov_b32 v120, v80
    v_mov_b32 v113, v49
    v_mov_b32 v121, v81
    v_mov_b32 v114, v50
    v_mov_b32 v122, v82
    v_mov_b32 v115, v51
    v_mov_b32 v123, v83
    v_mov_b32 v116, v52
    v_mov_b32 v124, v84
    v_mov_b32 v117, v53
    v_mov_b32 v125, v85
    v_mov_b32 v118, v54
    v_mov_b32 v126, v86
    v_mov_b32 v119, v55
    v_mov_b32 v127, v87
    s_lshl_b32 s31, s50, 16
    s_add_u32 s31, s31, 0
    v_add_u32 v33, s31, v1
    s_waitcnt lgkmcnt(0)
    s_barrier
    ds_read_b128 v[128:131], v33 offset:4096
    ds_read_b128 v[132:135], v33 offset:5120
    ds_read_b128 v[136:139], v33 offset:6144
    ds_read_b128 v[140:143], v33 offset:7168
    ds_read_b128 v[144:147], v33 offset:8192
    ds_read_b128 v[148:151], v33 offset:9216
    ds_read_b128 v[152:155], v33 offset:10240
    ds_read_b128 v[156:159], v33 offset:11264
    ds_read_b128 v[160:163], v33 offset:12288
    ds_read_b128 v[164:167], v33 offset:13312
    ds_read_b128 v[168:171], v33 offset:14336
    ds_read_b128 v[172:175], v33 offset:15360
    s_waitcnt lgkmcnt(8)
    v_add_f32 v112, v112, v128
    v_add_f32 v120, v120, v136
    v_add_f32 v113, v113, v129
    v_add_f32 v121, v121, v137
    v_add_f32 v114, v114, v130
    v_add_f32 v122, v122, v138
    v_add_f32 v115, v115, v131
    v_add_f32 v123, v123, v139
    v_add_f32 v116, v116, v132
    v_add_f32 v124, v124, v140
    v_add_f32 v117, v117, v133
    v_add_f32 v125, v125, v141
    v_add_f32 v118, v118, v134
    v_add_f32 v126, v126, v142
    v_add_f32 v119, v119, v135
    v_add_f32 v127, v127, v143
    s_waitcnt lgkmcnt(4)
    v_add_f32 v112, v112, v144
    v_add_f32 v120, v120, v152
    v_add_f32 v113, v113, v145
    v_add_f32 v121, v121, v153
    v_add_f32 v114, v114, v146
    v_add_f32 v122, v122, v154
    v_add_f32 v115, v115, v147
    v_add_f32 v123, v123, v155
    v_add_f32 v116, v116, v148
    v_add_f32 v124, v124, v156
    v_add_f32 v117, v117, v149
    v_add_f32 v125, v125, v157
    v_add_f32 v118, v118, v150
    v_add_f32 v126, v126, v158
    v_add_f32 v119, v119, v151
    v_add_f32 v127, v127, v159
    s_waitcnt lgkmcnt(0)
    v_add_f32 v112, v112, v160
    v_add_f32 v120, v120, v168
    v_add_f32 v113, v113, v161
    v_add_f32 v121, v121, v169
    v_add_f32 v114, v114, v162
    v_add_f32 v122, v122, v170
    v_add_f32 v115, v115, v163
    v_add_f32 v123, v123, v171
    v_add_f32 v116, v116, v164
    v_add_f32 v124, v124, v172
    v_add_f32 v117, v117, v165
    v_add_f32 v125, v125, v173
    v_add_f32 v118, v118, v166
    v_add_f32 v126, v126, v174
    v_add_f32 v119, v119, v167
    v_add_f32 v127, v127, v175
    s_branch L_C_fin
L_C_q1:
    s_cmp_eq_u32 s51, 1
    s_cbranch_scc0 L_C_q2
    ds_write_b128 v32, v[48:51] offset:0
    ds_write_b128 v32, v[52:55] offset:1024
    ds_write_b128 v32, v[80:83] offset:2048
    ds_write_b128 v32, v[84:87] offset:3072
    ds_write_b128 v32, v[64:67] offset:32768
    ds_write_b128 v32, v[68:71] offset:33792
    ds_write_b128 v32, v[96:99] offset:34816
    ds_write_b128 v32, v[100:103] offset:35840
    ds_write_b128 v32, v[72:75] offset:49152
    ds_write_b128 v32, v[76:79] offset:50176
    ds_write_b128 v32, v[104:107] offset:51200
    ds_write_b128 v32, v[108:111] offset:52224
    v_mov_b32 v112, v56
    v_mov_b32 v120, v88
    v_mov_b32 v113, v57
    v_mov_b32 v121, v89
    v_mov_b32 v114, v58
    v_mov_b32 v122, v90
    v_mov_b32 v115, v59
    v_mov_b32 v123, v91
    v_mov_b32 v116, v60
    v_mov_b32 v124, v92
    v_mov_b32 v117, v61
    v_mov_b32 v125, v93
    v_mov_b32 v118, v62
    v_mov_b32 v126, v94
    v_mov_b32 v119, v63
    v_mov_b32 v127, v95
    s_lshl_b32 s31, s50, 16
    s_add_u32 s31, s31, 16384
    v_add_u32 v33, s31, v1
    s_waitcnt lgkmcnt(0)
    s_barrier
    ds_read_b128 v[128:131], v33 offset:0
    ds_read_b128 v[132:135], v33 offset:1024
    ds_read_b128 v[136:139], v33 offset:2048
    ds_read_b128 v[140:143], v33 offset:3072
    ds_read_b128 v[144:147], v33 offset:8192
    ds_read_b128 v[148:151], v33 offset:9216
    ds_read_b128 v[152:155], v33 offset:10240
    ds_read_b128 v[156:159], v33 offset:11264
    ds_read_b128 v[160:163], v33 offset:12288
    ds_read_b128 v[164:167], v33 offset:13312
    ds_read_b128 v[168:171], v33 offset:14336
    ds_read_b128 v[172:175], v33 offset:15360
    s_waitcnt lgkmcnt(8)
    v_add_f32 v112, v112, v128
    v_add_f32 v120, v120, v136
    v_add_f32 v113, v113, v129
    v_add_f32 v121, v121, v137
    v_add_f32 v114, v114, v130
    v_add_f32 v122, v122, v138
    v_add_f32 v115, v115, v131
    v_add_f32 v123, v123, v139
    v_add_f32 v116, v116, v132
    v_add_f32 v124, v124, v140
    v_add_f32 v117, v117, v133
    v_add_f32 v125, v125, v141
    v_add_f32 v118, v118, v134
    v_add_f32 v126, v126, v142
    v_add_f32 v119, v119, v135
    v_add_f32 v127, v127, v143
    s_waitcnt lgkmcnt(4)
    v_add_f32 v112, v112, v144
    v_add_f32 v120, v120, v152
    v_add_f32 v113, v113, v145
    v_add_f32 v121, v121, v153
    v_add_f32 v114, v114, v146
    v_add_f32 v122, v122, v154
    v_add_f32 v115, v115, v147
    v_add_f32 v123, v123, v155
    v_add_f32 v116, v116, v148
    v_add_f32 v124, v124, v156
    v_add_f32 v117, v117, v149
    v_add_f32 v125, v125, v157
    v_add_f32 v118, v118, v150
    v_add_f32 v126, v126, v158
    v_add_f32 v119, v119, v151
    v_add_f32 v127, v127, v159
    s_waitcnt lgkmcnt(0)
    v_add_f32 v112, v112, v160
    v_add_f32 v120, v120, v168
    v_add_f32 v113, v113, v161
    v_add_f32 v121, v121, v169
    v_add_f32 v114, v114, v162
    v_add_f32 v122, v122, v170
    v_add_f32 v115, v115, v163
    v_add_f32 v123, v123, v171
    v_add_f32 v116, v116, v164
    v_add_f32 v124, v124, v172
    v_add_f32 v117, v117, v165
    v_add_f32 v125, v125, v173
    v_add_f32 v118, v118, v166
    v_add_f32 v126, v126, v174
    v_add_f32 v119, v119, v167
    v_add_f32 v127, v127, v175
    s_branch L_C_fin
L_C_q2:
    s_cmp_eq_u32 s51, 2
    s_cbranch_scc0 L_C_q3
    ds_write_b128 v32, v[48:51] offset:0
    ds_write_b128 v32, v[52:55] offset:1024
    ds_write_b128 v32, v[80:83] offset:2048
    ds_write_b128 v32, v[84:87] offset:3072
    ds_write_b128 v32, v[56:59] offset:16384
    ds_write_b128 v32, v[60:63] offset:17408
    ds_write_b128 v32, v[88:91] offset:18432
    ds_write_b128 v32, v[92:95] offset:19456
    ds_write_b128 v32, v[72:75] offset:49152
    ds_write_b128 v32, v[76:79] offset:50176
    ds_write_b128 v32, v[104:107] offset:51200
    ds_write_b128 v32, v[108:111] offset:52224
    v_mov_b32 v112, v64
    v_mov_b32 v120, v96
    v_mov_b32 v113, v65
    v_mov_b32 v121, v97
    v_mov_b32 v114, v66
    v_mov_b32 v122, v98
    v_mov_b32 v115, v67
    v_mov_b32 v123, v99
    v_mov_b32 v116, v68
    v_mov_b32 v124, v100
    v_mov_b32 v117, v69
    v_mov_b32 v125, v101
    v_mov_b32 v118, v70
    v_mov_b32 v126, v102
    v_mov_b32 v119, v71
    v_mov_b32 v127, v103
    s_lshl_b32 s31, s50, 16
    s_add_u32 s31, s31, 32768
    v_add_u32 v33, s31, v1
    s_waitcnt lgkmcnt(0)
    s_barrier
    ds_read_b128 v[128:131], v33 offset:0
    ds_read_b128 v[132:135], v33 offset:1024
    ds_read_b128 v[136:139], v33 offset:2048
    ds_read_b128 v[140:143], v33 offset:3072
    ds_read_b128 v[144:147], v33 offset:4096
    ds_read_b128 v[148:151], v33 offset:5120
    ds_read_b128 v[152:155], v33 offset:6144
    ds_read_b128 v[156:159], v33 offset:7168
    ds_read_b128 v[160:163], v33 offset:12288
    ds_read_b128 v[164:167], v33 offset:13312
    ds_read_b128 v[168:171], v33 offset:14336
    ds_read_b128 v[172:175], v33 offset:15360
    s_waitcnt lgkmcnt(8)
    v_add_f32 v112, v112, v128
    v_add_f32 v120, v120, v136
    v_add_f32 v113, v113, v129
    v_add_f32 v121, v121, v137
    v_add_f32 v114, v114, v130
    v_add_f32 v122, v122, v138
    v_add_f32 v115, v115, v131
    v_add_f32 v123, v123, v139
    v_add_f32 v116, v116, v132
    v_add_f32 v124, v124, v140
    v_add_f32 v117, v117, v133
    v_add_f32 v125, v125, v141
    v_add_f32 v118, v118, v134
    v_add_f32 v126, v126, v142
    v_add_f32 v119, v119, v135
    v_add_f32 v127, v127, v143
    s_waitcnt lgkmcnt(4)
    v_add_f32 v112, v112, v144
    v_add_f32 v120, v120, v152
    v_add_f32 v113, v113, v145
    v_add_f32 v121, v121, v153
    v_add_f32 v114, v114, v146
    v_add_f32 v122, v122, v154
    v_add_f32 v115, v115, v147
    v_add_f32 v123, v123, v155
    v_add_f32 v116, v116, v148
    v_add_f32 v124, v124, v156
    v_add_f32 v117, v117, v149
    v_add_f32 v125, v125, v157
    v_add_f32 v118, v118, v150
    v_add_f32 v126, v126, v158
    v_add_f32 v119, v119, v151
    v_add_f32 v127, v127, v159
    s_waitcnt lgkmcnt(0)
    v_add_f32 v112, v112, v160
    v_add_f32 v120, v120, v168
    v_add_f32 v113, v113, v161
    v_add_f32 v121, v121, v169
    v_add_f32 v114, v114, v162
    v_add_f32 v122, v122, v170
    v_add_f32 v115, v115, v163
    v_add_f32 v123, v123, v171
    v_add_f32 v116, v116, v164
    v_add_f32 v124, v124, v172
    v_add_f32 v117, v117, v165
    v_add_f32 v125, v125, v173
    v_add_f32 v118, v118, v166
    v_add_f32 v126, v126, v174
    v_add_f32 v119, v119, v167
    v_add_f32 v127, v127, v175
    s_branch L_C_fin
L_C_q3:
    ds_write_b128 v32, v[48:51] offset:0
    ds_write_b128 v32, v[52:55] offset:1024
    ds_write_b128 v32, v[80:83] offset:2048
    ds_write_b128 v32, v[84:87] offset:3072
    ds_write_b128 v32, v[56:59] offset:16384
    ds_write_b128 v32, v[60:63] offset:17408
    ds_write_b128 v32, v[88:91] offset:18432
    ds_write_b128 v32, v[92:95] offset:19456
    ds_write_b128 v32, v[64:67] offset:32768
    ds_write_b128 v32, v[68:71] offset:33792
    ds_write_b128 v32, v[96:99] offset:34816
    ds_write_b128 v32, v[100:103] offset:35840
    v_mov_b32 v112, v72
    v_mov_b32 v120, v104
    v_mov_b32 v113, v73
    v_mov_b32 v121, v105
    v_mov_b32 v114, v74
    v_mov_b32 v122, v106
    v_mov_b32 v115, v75
    v_mov_b32 v123, v107
    v_mov_b32 v116, v76
    v_mov_b32 v124, v108
    v_mov_b32 v117, v77
    v_mov_b32 v125, v109
    v_mov_b32 v118, v78
    v_mov_b32 v126, v110
    v_mov_b32 v119, v79
    v_mov_b32 v127, v111
    s_lshl_b32 s31, s50, 16
    s_add_u32 s31, s31, 49152
    v_add_u32 v33, s31, v1
    s_waitcnt lgkmcnt(0)
    s_barrier
    ds_read_b128 v[128:131], v33 offset:0
    ds_read_b128 v[132:135], v33 offset:1024
    ds_read_b128 v[136:139], v33 offset:2048
    ds_read_b128 v[140:143], v33 offset:3072
    ds_read_b128 v[144:147], v33 offset:4096
    ds_read_b128 v[148:151], v33 offset:5120
    ds_read_b128 v[152:155], v33 offset:6144
    ds_read_b128 v[156:159], v33 offset:7168
    ds_read_b128 v[160:163], v33 offset:8192
    ds_read_b128 v[164:167], v33 offset:9216
    ds_read_b128 v[168:171], v33 offset:10240
    ds_read_b128 v[172:175], v33 offset:11264
    s_waitcnt lgkmcnt(8)
    v_add_f32 v112, v112, v128
    v_add_f32 v120, v120, v136
    v_add_f32 v113, v113, v129
    v_add_f32 v121, v121, v137
    v_add_f32 v114, v114, v130
    v_add_f32 v122, v122, v138
    v_add_f32 v115, v115, v131
    v_add_f32 v123, v123, v139
    v_add_f32 v116, v116, v132
    v_add_f32 v124, v124, v140
    v_add_f32 v117, v117, v133
    v_add_f32 v125, v125, v141
    v_add_f32 v118, v118, v134
    v_add_f32 v126, v126, v142
    v_add_f32 v119, v119, v135
    v_add_f32 v127, v127, v143
    s_waitcnt lgkmcnt(4)
    v_add_f32 v112, v112, v144
    v_add_f32 v120, v120, v152
    v_add_f32 v113, v113, v145
    v_add_f32 v121, v121, v153
    v_add_f32 v114, v114, v146
    v_add_f32 v122, v122, v154
    v_add_f32 v115, v115, v147
    v_add_f32 v123, v123, v155
    v_add_f32 v116, v116, v148
    v_add_f32 v124, v124, v156
    v_add_f32 v117, v117, v149
    v_add_f32 v125, v125, v157
    v_add_f32 v118, v118, v150
    v_add_f32 v126, v126, v158
    v_add_f32 v119, v119, v151
    v_add_f32 v127, v127, v159
    s_waitcnt lgkmcnt(0)
    v_add_f32 v112, v112, v160
    v_add_f32 v120, v120, v168
    v_add_f32 v113, v113, v161
    v_add_f32 v121, v121, v169
    v_add_f32 v114, v114, v162
    v_add_f32 v122, v122, v170
    v_add_f32 v115, v115, v163
    v_add_f32 v123, v123, v171
    v_add_f32 v116, v116, v164
    v_add_f32 v124, v124, v172
    v_add_f32 v117, v117, v165
    v_add_f32 v125, v125, v173
    v_add_f32 v118, v118, v166
    v_add_f32 v126, v126, v174
    v_add_f32 v119, v119, v167
    v_add_f32 v127, v127, v175
L_C_fin:
    v_mul_f32 v176, 0xbfb8aa3b, v120
    v_mul_f32 v177, 0xbfb8aa3b, v121
    v_mul_f32 v178, 0xbfb8aa3b, v122
    v_mul_f32 v179, 0xbfb8aa3b, v123
    v_mul_f32 v180, 0xbfb8aa3b, v124
    v_mul_f32 v181, 0xbfb8aa3b, v125
    v_mul_f32 v182, 0xbfb8aa3b, v126
    v_mul_f32 v183, 0xbfb8aa3b, v127
    v_exp_f32 v176, v176
    v_exp_f32 v177, v177
    v_exp_f32 v178, v178
    v_exp_f32 v179, v179
    v_exp_f32 v180, v180
    v_exp_f32 v181, v181
    v_exp_f32 v182, v182
    v_exp_f32 v183, v183
    v_add_f32 v176, 1.0, v176
    v_add_f32 v177, 1.0, v177
    v_add_f32 v178, 1.0, v178
    v_add_f32 v179, 1.0, v179
    v_add_f32 v180, 1.0, v180
    v_add_f32 v181, 1.0, v181
    v_add_f32 v182, 1.0, v182
    v_add_f32 v183, 1.0, v183
    v_rcp_f32 v176, v176
    v_rcp_f32 v177, v177
    v_rcp_f32 v178, v178
    v_rcp_f32 v179, v179
    v_rcp_f32 v180, v180
    v_rcp_f32 v181, v181
    v_rcp_f32 v182, v182
    v_rcp_f32 v183, v183
    v_mul_f32 v176, v120, v176
    v_mul_f32 v177, v121, v177
    v_mul_f32 v178, v122, v178
    v_mul_f32 v179, v123, v179
    v_mul_f32 v180, v124, v180
    v_mul_f32 v181, v125, v181
    v_mul_f32 v182, v126, v182
    v_mul_f32 v183, v127, v183
    v_lshlrev_b32 v128, 16, v220
    v_and_b32 v129, 0xffff0000, v220
    v_lshlrev_b32 v130, 16, v221
    v_and_b32 v131, 0xffff0000, v221
    v_lshlrev_b32 v132, 16, v222
    v_and_b32 v133, 0xffff0000, v222
    v_lshlrev_b32 v134, 16, v223
    v_and_b32 v135, 0xffff0000, v223
    v_fma_f32 v128, v112, v176, v128
    v_fma_f32 v129, v113, v177, v129
    v_fma_f32 v130, v114, v178, v130
    v_fma_f32 v131, v115, v179, v131
    v_fma_f32 v132, v116, v180, v132
    v_fma_f32 v133, v117, v181, v133
    v_fma_f32 v134, v118, v182, v134
    v_fma_f32 v135, v119, v183, v135
    v_cvt_pk_bf16_f32 v220, v128, v129
    v_cvt_pk_bf16_f32 v221, v130, v131
    v_cvt_pk_bf16_f32 v222, v132, v133
    v_cvt_pk_bf16_f32 v223, v134, v135
    s_mov_b32 s8, s96
    s_and_b32 s9, s97, 0xffff
    s_mov_b32 s10, 2097152
    s_mov_b32 s11, 0x20000
    buffer_store_dwordx2 v[220:221], v43, s[8:11], s56 offen
    buffer_store_dwordx2 v[222:223], v43, s[8:11], s56 offen offset:16
    s_mov_b32 s32, 16384
    s_or_b32 s31, s2, s24
    s_cmp_eq_u32 s31, 0
    s_cselect_b32 s31, s32, 2130706432
    v_mov_b32 v38, s29
    v_mov_b32 v39, 0
    s_mov_b64 exec, 1
    buffer_store_dword v38, v39, s[12:15], s31 offen sc1
    s_mov_b64 exec, -1
    s_waitcnt vmcnt(0)
    s_waitcnt vmcnt(0)
L_end:
    s_endpgm
L_codeend:
.section .rodata,"a"
.p2align 6
.amdhsa_kernel recurrent_scan__linear_attn_block__mixer_gmlp__prompt_kernel
  .amdhsa_next_free_vgpr 256
  .amdhsa_next_free_sgpr 102
  .amdhsa_accum_offset 256
  .amdhsa_group_segment_fixed_size 0
  .amdhsa_kernarg_size 88
  .amdhsa_user_sgpr_count 2
  .amdhsa_user_sgpr_kernarg_segment_ptr 1
  .amdhsa_system_sgpr_workgroup_id_x 1
.end_amdhsa_kernel
```
